```python
import torch

def _softmax(x, axis=-1):
    return torch.softmax(x, dim=axis)

def _gelu(x):
    return torch.nn.functional.gelu(x, approximate='tanh')

def _silu(x):
    return torch.nn.functional.silu(x)

def _sigmoid(x):
    return torch.sigmoid(x)

def _layernorm(x, axis=-1, eps=1e-05):
    m = x.mean(dim=axis, keepdim=True)
    v = x.var(dim=axis, keepdim=True, unbiased=False)
    return (x - m) / torch.sqrt(v + eps)

def _scatter_add(tgt, idx, src, axis=0):
    return tgt.clone().index_add_(axis, idx, src)

def _segment_sum(src, seg, n):
    out = torch.zeros((n,) + src.shape[1:], dtype=src.dtype)
    return out.index_add_(0, seg, src)

def _pad(x, pw):
    flat = tuple((v for pair in reversed(pw) for v in pair))
    return torch.nn.functional.pad(x, flat)
kernel_name = 'standalone__molecular_angular_painn__graph'

def setup_inputs():

    _w = lambda a: (lambda t: t.to(torch.bfloat16) if t.is_floating_point() else t)(torch.as_tensor(a))
    N, deg, D = (25000, 16, 128)
    n_rbf = max(4, 4)
    E = N * deg
    cutoff = 5.0
    freqs = (torch.arange(1, n_rbf + 1) * torch.pi / cutoff).to(float)
    return {'sv': _w((lambda *s: torch.randn(*s, dtype=torch.bfloat16) * 0.4)(N, 4, D) * 0.3), 'pos': _w((lambda *s: torch.randn(*s, dtype=torch.bfloat16) * 3.2)(N, 3) * 1.2), 'src': _w((lambda lo, hi, *s: torch.randint(lo, hi, s))(0, N, E).to(torch.int64)), 'dst': _w((lambda lo, hi, *s: torch.randint(lo, hi, s))(0, N, E).to(torch.int64)), 'freqs': _w(freqs), 'w_phi1': _w((lambda *s: torch.randn(*s, dtype=torch.bfloat16) * 3.2)(D, D) / D ** 0.5), 'w_phi2': _w((lambda *s: torch.randn(*s, dtype=torch.bfloat16) * 3.2)(D, 3 * D) / D ** 0.5), 'w_rbf': _w((lambda *s: torch.randn(*s, dtype=torch.bfloat16) * 3.2)(n_rbf, 3 * D) / n_rbf ** 0.5)}

def reference(sv, pos, src, dst, freqs, w_phi1, w_phi2, w_rbf):
    N, _, D = sv.shape
    E = src.shape[0]
    PI, cutoff = (3.141592653589793, 5.0)
    s, v = (sv[:, 0, :].clone(), sv[:, 1:, :].clone())
    r_vec = pos[src] - pos[dst]
    d = torch.sqrt((r_vec * r_vec).sum(-1) + 1e-08)
    r_hat = r_vec / d[:, None]
    rbf = torch.sin(d[:, None] * freqs[None, :]) / d[:, None]
    fcut = 0.5 * (torch.cos(PI * d / cutoff) + 1.0)
    fcut = torch.where(d < cutoff, fcut, 0.0 * d)
    Wf = rbf @ w_rbf * fcut[:, None]
    phi = (_silu(s @ w_phi1) @ w_phi2)[src]
    m = phi * Wf
    m_s, m_vv, m_vr = (m[:, :D].clone(), m[:, D:2 * D].clone(), m[:, 2 * D:].clone())
    ds = _segment_sum(m_s, dst, N)
    dv_e = m_vv[:, None, :] * v[src] + m_vr[:, None, :] * r_hat[:, :, None]
    dv = _segment_sum(dv_e.reshape(E, 3 * D), dst, N).reshape(N, 3, D)
    return sv + torch.concatenate([ds[:, None, :], dv], axis=1)
```

```asm
; @launch kernel=edge_bin_kernel grid=(256,1,1) block=(1024,1,1) lds=152576
; @launch kernel=message_kernel grid=(256,1,1) block=(512,1,1) lds=162944
.amdgcn_target "amdgcn-amd-amdhsa--gfx950"
.text
.globl edge_bin_kernel
.p2align 8
.type edge_bin_kernel,@function
edge_bin_kernel:
    s_cmp_ge_u32 s2, 256
    s_cbranch_scc1 K1_END
    s_load_dwordx2 s[24:25], s[0:1], 16
    s_load_dwordx2 s[28:29], s[0:1], 24
    s_load_dwordx2 s[20:21], s[0:1], 8
    s_load_dwordx2 s[36:37], s[0:1], 40
    s_load_dwordx2 s[84:85], s[0:1], 0
    v_lshrrev_b32 v1, 6, v0
    v_and_b32 v6, 63, v0
    s_lshr_b32 s53, s2, 4
    v_readfirstlane_b32 s3, v1
    s_lshl_b32 s53, s53, 3
    s_and_b32 s54, s2, 7
    s_or_b32 s73, s53, s54
    v_lshlrev_b32 v9, 4, v6
    s_mov_b32 s27, 0x00020000
    s_bitcmp1_b32 s2, 3
    s_cbranch_scc1 K1_HROLE
    s_cmp_ge_u32 s73, 125
    s_cbranch_scc1 K1_HROLE2
    s_mov_b32 s26, 1600000
    s_mov_b32 s30, s26
    s_mov_b32 s31, s27
    s_mul_i32 s53, s73, 12800
    v_lshlrev_b32 v7, 4, v0
    v_cmp_gt_u32 vcc, 800, v0
    v_mov_b32 v8, 0x40000000
    s_mov_b64 s[50:51], vcc
    v_cndmask_b32 v7, v8, v7, vcc
    s_mov_b32 s22, 150000
    s_mov_b32 s23, s27
    s_waitcnt lgkmcnt(0)
    buffer_load_dwordx4 v[56:59], v7, s[24:27], s53 offen
    buffer_load_dwordx4 v[60:63], v7, s[28:31], s53 offen
    s_lshr_b32 s54, s73, 3
    s_mul_i32 s54, s54, 5
    s_lshr_b32 s54, s54, 3
    s_lshl_b32 s54, s54, 4
    s_add_u32 s54, s54, s3
    s_lshl_b32 m0, s54, 10
    s_movk_i32 s56, 10
K1_STG:
    s_cmp_ge_u32 m0, 150528
    s_cbranch_scc1 K1_SKIP
    buffer_load_dwordx4 v9, s[20:23], m0 offen lds
K1_SKIP:
    s_add_u32 m0, m0, 0x4000
    s_sub_u32 s54, m0, 163840
    s_cselect_b32 m0, m0, s54
    s_sub_u32 s56, s56, 1
    s_cmp_lg_u32 s56, 0
    s_cbranch_scc1 K1_STG
    s_load_dwordx2 s[32:33], s[0:1], 80
    s_load_dwordx2 s[10:11], s[0:1], 32
    s_load_dwordx2 s[40:41], s[0:1], 48
    s_load_dwordx2 s[44:45], s[0:1], 56
    s_mov_b32 s52, 0xffff0000
    s_mov_b32 s86, 25600000
    s_mov_b32 s87, s27
    s_mov_b32 s34, 33554432
    s_mov_b32 s35, s27
    s_mov_b32 s42, 98304
    s_mov_b32 s43, s27
    s_mov_b32 s46, 3072
    s_mov_b32 s47, s27
    s_mov_b32 s90, 6400000
    s_mov_b32 s91, s27
    s_waitcnt lgkmcnt(0)
    s_add_u32 s88, s32, 14680064
    s_addc_u32 s89, s33, 0
    s_load_dwordx2 s[48:49], s[10:11], 0
    v_lshlrev_b32 v10, 2, v0
    v_add_u32 v10, 150528, v10
    v_mov_b32 v11, 0
    v_cmp_gt_u32 vcc, 256, v0
    s_nop 0
    s_and_saveexec_b64 s[56:57], vcc
    ds_write_b32 v10, v11
    s_mov_b64 exec, s[56:57]
    s_mov_b32 s55, 43980480
    s_mov_b32 s58, 150528
    s_movk_i32 s59, 0x200
    v_mov_b32 v5, 1
    s_mov_b64 s[60:61], 0
    s_mov_b64 s[62:63], 0
    s_mov_b64 s[64:65], 0
    s_mov_b64 s[66:67], 0
    s_waitcnt vmcnt(9)
    v_mul_u32_u24 v64, 6, v56
    v_and_b32 v64, -4, v64
    v_and_b32 v72, 1, v56
    v_lshlrev_b32 v72, 4, v72
    v_mul_u32_u24 v65, 6, v57
    v_and_b32 v65, -4, v65
    v_and_b32 v73, 1, v57
    v_lshlrev_b32 v73, 4, v73
    v_mul_u32_u24 v66, 6, v58
    v_and_b32 v66, -4, v66
    v_and_b32 v74, 1, v58
    v_lshlrev_b32 v74, 4, v74
    v_mul_u32_u24 v67, 6, v59
    v_and_b32 v67, -4, v67
    v_and_b32 v75, 1, v59
    v_lshlrev_b32 v75, 4, v75
    v_mul_u32_u24 v68, 6, v60
    v_and_b32 v68, -4, v68
    v_and_b32 v76, 1, v60
    v_lshlrev_b32 v76, 4, v76
    v_mul_u32_u24 v69, 6, v61
    v_and_b32 v69, -4, v69
    v_and_b32 v77, 1, v61
    v_lshlrev_b32 v77, 4, v77
    v_mul_u32_u24 v70, 6, v62
    v_and_b32 v70, -4, v70
    v_and_b32 v78, 1, v62
    v_lshlrev_b32 v78, 4, v78
    v_mul_u32_u24 v71, 6, v63
    v_and_b32 v71, -4, v71
    v_and_b32 v79, 1, v63
    v_lshlrev_b32 v79, 4, v79
    v_mul_hi_u32 v80, v60, s55
    v_lshl_add_u32 v80, v80, 2, s58
    v_mov_b32 v104, v56
    v_mov_b32 v105, v60
    v_mul_hi_u32 v81, v61, s55
    v_lshl_add_u32 v81, v81, 2, s58
    v_mov_b32 v108, v57
    v_mov_b32 v109, v61
    v_mul_hi_u32 v82, v62, s55
    v_lshl_add_u32 v82, v82, 2, s58
    v_mov_b32 v112, v58
    v_mov_b32 v113, v62
    v_mul_hi_u32 v83, v63, s55
    v_lshl_add_u32 v83, v83, 2, s58
    v_mov_b32 v116, v59
    v_mov_b32 v117, v63
    s_waitcnt vmcnt(0) lgkmcnt(0)
    s_barrier
    s_mov_b64 exec, s[50:51]
    s_cbranch_execz K1_PHASE_B
    ds_read2_b32 v[88:89], v64 offset0:0 offset1:1
    ds_read2_b32 v[96:97], v68 offset0:0 offset1:1
    ds_read2_b32 v[90:91], v65 offset0:0 offset1:1
    ds_read2_b32 v[98:99], v69 offset0:0 offset1:1
    ds_read2_b32 v[92:93], v66 offset0:0 offset1:1
    ds_read2_b32 v[100:101], v70 offset0:0 offset1:1
    ds_read2_b32 v[94:95], v67 offset0:0 offset1:1
    ds_read2_b32 v[102:103], v71 offset0:0 offset1:1
    s_waitcnt lgkmcnt(7)
    v_lshrrev_b64 v[88:89], v72, v[88:89]
    s_waitcnt lgkmcnt(6)
    v_lshrrev_b64 v[96:97], v76, v[96:97]
    v_lshlrev_b32 v12, 16, v88
    v_lshlrev_b32 v13, 16, v96
    v_and_b32 v14, s52, v88
    v_and_b32 v15, s52, v96
    v_lshlrev_b32 v16, 16, v89
    v_lshlrev_b32 v17, 16, v97
    v_sub_f32 v12, v12, v13
    v_sub_f32 v14, v14, v15
    v_sub_f32 v107, v16, v17
    v_cvt_pk_bf16_f32 v106, v12, v14
    v_mul_f32 v13, v12, v12
    v_fmac_f32 v13, v14, v14
    v_fmac_f32 v13, v107, v107
    v_cmp_nlt_f32 vcc, 0x41c20000, v13
    v_cmp_class_f32_e64 s[60:61], v13, s59
    s_nop 0
    s_or_b64 s[60:61], s[60:61], vcc
    s_mov_b64 exec, s[60:61]
    ds_add_rtn_u32 v84, v80, v5
    s_mov_b64 exec, s[50:51]
    s_waitcnt lgkmcnt(6)
    v_lshrrev_b64 v[90:91], v73, v[90:91]
    s_waitcnt lgkmcnt(5)
    v_lshrrev_b64 v[98:99], v77, v[98:99]
    v_lshlrev_b32 v20, 16, v90
    v_lshlrev_b32 v21, 16, v98
    v_and_b32 v22, s52, v90
    v_and_b32 v23, s52, v98
    v_lshlrev_b32 v24, 16, v91
    v_lshlrev_b32 v25, 16, v99
    v_sub_f32 v20, v20, v21
    v_sub_f32 v22, v22, v23
    v_sub_f32 v111, v24, v25
    v_cvt_pk_bf16_f32 v110, v20, v22
    v_mul_f32 v21, v20, v20
    v_fmac_f32 v21, v22, v22
    v_fmac_f32 v21, v111, v111
    v_cmp_nlt_f32 vcc, 0x41c20000, v21
    v_cmp_class_f32_e64 s[62:63], v21, s59
    s_nop 0
    s_or_b64 s[62:63], s[62:63], vcc
    s_mov_b64 exec, s[62:63]
    ds_add_rtn_u32 v85, v81, v5
    s_mov_b64 exec, s[50:51]
    s_waitcnt lgkmcnt(5)
    v_lshrrev_b64 v[92:93], v74, v[92:93]
    s_waitcnt lgkmcnt(4)
    v_lshrrev_b64 v[100:101], v78, v[100:101]
    v_lshlrev_b32 v28, 16, v92
    v_lshlrev_b32 v29, 16, v100
    v_and_b32 v30, s52, v92
    v_and_b32 v31, s52, v100
    v_lshlrev_b32 v32, 16, v93
    v_lshlrev_b32 v33, 16, v101
    v_sub_f32 v28, v28, v29
    v_sub_f32 v30, v30, v31
    v_sub_f32 v115, v32, v33
    v_cvt_pk_bf16_f32 v114, v28, v30
    v_mul_f32 v29, v28, v28
    v_fmac_f32 v29, v30, v30
    v_fmac_f32 v29, v115, v115
    v_cmp_nlt_f32 vcc, 0x41c20000, v29
    v_cmp_class_f32_e64 s[64:65], v29, s59
    s_nop 0
    s_or_b64 s[64:65], s[64:65], vcc
    s_mov_b64 exec, s[64:65]
    ds_add_rtn_u32 v86, v82, v5
    s_mov_b64 exec, s[50:51]
    s_waitcnt lgkmcnt(4)
    v_lshrrev_b64 v[94:95], v75, v[94:95]
    s_waitcnt lgkmcnt(3)
    v_lshrrev_b64 v[102:103], v79, v[102:103]
    v_lshlrev_b32 v36, 16, v94
    v_lshlrev_b32 v37, 16, v102
    v_and_b32 v38, s52, v94
    v_and_b32 v39, s52, v102
    v_lshlrev_b32 v40, 16, v95
    v_lshlrev_b32 v41, 16, v103
    v_sub_f32 v36, v36, v37
    v_sub_f32 v38, v38, v39
    v_sub_f32 v119, v40, v41
    v_cvt_pk_bf16_f32 v118, v36, v38
    v_mul_f32 v37, v36, v36
    v_fmac_f32 v37, v38, v38
    v_fmac_f32 v37, v119, v119
    v_cmp_nlt_f32 vcc, 0x41c20000, v37
    v_cmp_class_f32_e64 s[66:67], v37, s59
    s_nop 0
    s_or_b64 s[66:67], s[66:67], vcc
    s_mov_b64 exec, s[66:67]
    ds_add_rtn_u32 v87, v83, v5
    s_mov_b64 exec, s[50:51]
    s_waitcnt lgkmcnt(0)
K1_PHASE_B:
    s_mov_b64 exec, -1
    s_barrier
    s_cmp_lg_u32 s3, 15
    s_cbranch_scc1 K1_NODESC
    s_setprio 3
    v_add_u32 v10, 150528, v9
    ds_read_b128 v[12:15], v10
    s_waitcnt lgkmcnt(0)
    v_add_u32 v17, v12, v13
    v_add_u32 v18, v17, v14
    v_add_u32 v19, v18, v15
    v_mov_b32 v20, v19
    s_nop 1
    v_add_u32_dpp v20, v20, v20 row_shr:1 row_mask:0xf bank_mask:0xf bound_ctrl:0
    s_nop 1
    v_add_u32_dpp v20, v20, v20 row_shr:2 row_mask:0xf bank_mask:0xf bound_ctrl:0
    s_nop 1
    v_add_u32_dpp v20, v20, v20 row_shr:4 row_mask:0xf bank_mask:0xf bound_ctrl:0
    s_nop 1
    v_add_u32_dpp v20, v20, v20 row_shr:8 row_mask:0xf bank_mask:0xf bound_ctrl:0
    s_nop 1
    v_add_u32_dpp v20, v20, v20 row_bcast:15 row_mask:0xa bank_mask:0xf
    s_nop 1
    v_add_u32_dpp v20, v20, v20 row_bcast:31 row_mask:0xc bank_mask:0xf
    v_sub_u32 v24, v20, v19
    v_add_u32 v25, v24, v12
    v_add_u32 v26, v24, v17
    v_add_u32 v27, v24, v18
    ds_write_b128 v10, v[24:27] offset:1024
    ds_write_b32 v10, v20
    s_waitcnt lgkmcnt(0)
    s_barrier
    v_lshl_or_b32 v28, v12, 16, v24
    v_lshl_or_b32 v29, v13, 16, v25
    v_lshl_or_b32 v30, v14, 16, v26
    v_lshl_or_b32 v31, v15, 16, v27
    s_lshl_b32 s69, s73, 10
    s_add_u32 s69, s69, 262144
    buffer_store_dwordx4 v[28:31], v9, s[32:35], s69 offen
    s_nop 0
    s_branch K1_SCANNED
K1_NODESC:
    s_barrier
K1_SCANNED:
    v_mov_b32 v20, 151536
    ds_read_b32 v20, v20
    s_mov_b64 exec, s[60:61]
    ds_read_b32 v12, v80 offset:1024
    s_mov_b64 exec, s[62:63]
    ds_read_b32 v13, v81 offset:1024
    s_mov_b64 exec, s[64:65]
    ds_read_b32 v14, v82 offset:1024
    s_mov_b64 exec, s[66:67]
    ds_read_b32 v15, v83 offset:1024
    s_mov_b64 exec, s[60:61]
    s_waitcnt lgkmcnt(3)
    v_add_lshl_u32 v12, v12, v84, 4
    ds_write_b128 v12, v[104:107]
    s_mov_b64 exec, s[62:63]
    s_waitcnt lgkmcnt(3)
    v_add_lshl_u32 v13, v13, v85, 4
    ds_write_b128 v13, v[108:111]
    s_mov_b64 exec, s[64:65]
    s_waitcnt lgkmcnt(3)
    v_add_lshl_u32 v14, v14, v86, 4
    ds_write_b128 v14, v[112:115]
    s_mov_b64 exec, s[66:67]
    s_waitcnt lgkmcnt(3)
    v_add_lshl_u32 v15, v15, v87, 4
    ds_write_b128 v15, v[116:119]
    s_mov_b64 exec, -1
    v_readfirstlane_b32 s68, v20
    s_lshl_b32 s60, s48, 16
    s_and_b32 s61, s48, s52
    s_lshl_b32 s62, s49, 16
    s_and_b32 s63, s49, s52
    s_mul_i32 s69, s73, 102400
    s_add_u32 s69, s69, 1048576
    s_movk_i32 s70, 3125
    s_mov_b32 s71, 0x40a00000
    s_waitcnt lgkmcnt(0)
    s_barrier
    v_mov_b32 v8, v0
    s_lshl_b32 s72, s3, 6
    s_nop 0
K1_DENSE:
    s_cmp_ge_u32 s72, s68
    s_cbranch_scc1 K1_FIN
    v_cmp_gt_u32 vcc, s68, v8
    s_nop 0
    s_and_b64 exec, exec, vcc
    v_lshlrev_b32 v10, 4, v8
    ds_read_b128 v[12:15], v10
    v_lshlrev_b32 v11, 5, v8
    s_waitcnt lgkmcnt(0)
    v_lshlrev_b32 v16, 16, v14
    v_and_b32 v17, s52, v14
    v_cvt_pk_bf16_f32 v15, v15, v15
    v_mul_f32 v18, v16, v16
    v_mul_f32 v19, v17, v17
    v_and_b32 v15, s52, v15
    v_cvt_pk_bf16_f32 v18, v18, v19
    v_mul_f32 v20, v15, v15
    v_and_b32 v19, s52, v18
    v_cvt_pk_bf16_f32 v20, v20, v20
    v_lshlrev_b32 v18, 16, v18
    v_and_b32 v20, s52, v20
    v_add_f32 v18, v18, v19
    v_add_f32 v18, v18, v20
    v_cvt_pk_bf16_f32 v18, v18, v18
    v_and_b32 v18, s52, v18
    v_add_f32 v18, 0x322bcc77, v18
    v_cvt_pk_bf16_f32 v18, v18, v18
    v_and_b32 v18, s52, v18
    v_sqrt_f32 v18, v18
    s_nop 0
    v_cvt_pk_bf16_f32 v18, v18, v18
    v_and_b32 v18, s52, v18
    v_mul_f32 v26, 0x40490fdb, v18
    v_cvt_pk_bf16_f32 v26, v26, v26
    v_mul_f32 v22, s60, v18
    v_mul_f32 v23, s61, v18
    v_mul_f32 v24, s62, v18
    v_mul_f32 v25, s63, v18
    v_and_b32 v26, s52, v26
    v_cvt_pk_bf16_f32 v22, v22, v23
    v_cvt_pk_bf16_f32 v24, v24, v25
    v_mul_f32 v26, 0x3e4ccccd, v26
    v_and_b32 v23, s52, v22
    v_and_b32 v25, s52, v24
    v_cvt_pk_bf16_f32 v26, v26, v26
    v_lshlrev_b32 v22, 16, v22
    v_lshlrev_b32 v24, 16, v24
    v_and_b32 v26, s52, v26
    v_mul_f32 v22, 0.15915494, v22
    v_mul_f32 v23, 0.15915494, v23
    v_mul_f32 v24, 0.15915494, v24
    v_mul_f32 v25, 0.15915494, v25
    v_mul_f32 v26, 0.15915494, v26
    v_rndne_f32 v28, v22
    v_rndne_f32 v29, v23
    v_rndne_f32 v30, v24
    v_rndne_f32 v31, v25
    v_rndne_f32 v32, v26
    v_sub_f32 v22, v22, v28
    v_sub_f32 v23, v23, v29
    v_sub_f32 v24, v24, v30
    v_sub_f32 v25, v25, v31
    v_sub_f32 v26, v26, v32
    v_sin_f32 v22, v22
    v_sin_f32 v23, v23
    v_sin_f32 v24, v24
    v_sin_f32 v25, v25
    v_cos_f32 v26, v26
    v_cvt_pk_bf16_f32 v22, v22, v23
    v_cvt_pk_bf16_f32 v24, v24, v25
    v_cvt_pk_bf16_f32 v26, v26, v26
    v_rcp_f32 v19, v18
    v_and_b32 v23, s52, v22
    v_and_b32 v25, s52, v24
    v_and_b32 v26, s52, v26
    v_lshlrev_b32 v22, 16, v22
    v_lshlrev_b32 v24, 16, v24
    v_add_f32 v26, 1.0, v26
    v_mul_f32 v22, v22, v19
    v_mul_f32 v23, v23, v19
    v_mul_f32 v24, v24, v19
    v_mul_f32 v25, v25, v19
    v_cvt_pk_bf16_f32 v26, v26, v26
    v_cmp_gt_f32 vcc, s71, v18
    v_cvt_pk_bf16_f32 v22, v22, v23
    v_cvt_pk_bf16_f32 v24, v24, v25
    v_and_b32 v26, s52, v26
    v_and_b32 v23, s52, v22
    v_and_b32 v25, s52, v24
    v_mul_f32 v26, 0.5, v26
    v_mul_f32 v27, 0, v18
    v_lshlrev_b32 v22, 16, v22
    v_lshlrev_b32 v24, 16, v24
    v_cndmask_b32 v26, v27, v26, vcc
    v_mul_hi_u32 v21, v13, s55
    v_mul_f32 v22, v22, v26
    v_mul_f32 v23, v23, v26
    v_mul_f32 v24, v24, v26
    v_mul_f32 v25, v25, v26
    v_mul_u32_u24 v21, s70, v21
    v_cvt_pk_bf16_f32 v48, v22, v23
    v_cvt_pk_bf16_f32 v49, v24, v25
    v_add_u32 v21, 31, v21
    v_lshlrev_b32 v28, 16, v48
    v_and_b32 v29, s52, v48
    v_lshlrev_b32 v30, 16, v49
    v_and_b32 v31, s52, v49
    v_lshrrev_b32 v21, 5, v21
    v_mul_f32 v16, v16, v19
    v_mul_f32 v17, v17, v19
    v_mul_f32 v15, v15, v19
    v_sub_f32 v22, v22, v28
    v_sub_f32 v23, v23, v29
    v_sub_f32 v24, v24, v30
    v_sub_f32 v25, v25, v31
    v_lshlrev_b32 v44, 10, v12
    v_sub_u32 v45, v13, v21
    v_cvt_pk_bf16_f32 v46, v16, v17
    v_cvt_pk_bf16_f32 v47, v15, 0
    v_cvt_pk_bf16_f32 v50, v22, v23
    v_cvt_pk_bf16_f32 v51, v24, v25
    buffer_store_dwordx4 v[44:47], v11, s[32:35], s69 offen
    buffer_store_dwordx4 v[48:51], v11, s[32:35], s69 offen offset:16
    v_add_u32 v8, 0x400, v8
    s_add_u32 s72, s72, 0x400
    s_branch K1_DENSE
K1_WJOB:
    s_cmp_eq_u32 s74, 12
    s_cbranch_scc1 K1_WRBF
    v_mul_u32_u24 v10, 6144, v8
    v_lshl_add_u32 v10, v7, 4, v10
    v_add_u32 v11, 3072, v10
    s_and_b32 s55, s74, 3
    s_lshr_b32 s57, s74, 2
    s_mul_i32 s59, s55, 24576
    s_lshl_b32 s60, s57, 8
    s_add_u32 s59, s59, s60
    buffer_load_dwordx4 v[12:15], v10, s[40:43], s59 offen offset:0
    buffer_load_dwordx4 v[16:19], v10, s[40:43], s59 offen offset:768
    buffer_load_dwordx4 v[20:23], v10, s[40:43], s59 offen offset:1536
    buffer_load_dwordx4 v[24:27], v10, s[40:43], s59 offen offset:2304
    buffer_load_dwordx4 v[28:31], v11, s[40:43], s59 offen offset:0
    buffer_load_dwordx4 v[32:35], v11, s[40:43], s59 offen offset:768
    buffer_load_dwordx4 v[36:39], v11, s[40:43], s59 offen offset:1536
    buffer_load_dwordx4 v[40:43], v11, s[40:43], s59 offen offset:2304
    s_lshl_b32 s62, s57, 15
    s_lshl_b32 s60, s55, 10
    s_add_u32 s62, s62, s60
    s_waitcnt vmcnt(0)
    v_perm_b32 v48, v16, v12, s64
    v_perm_b32 v49, v24, v20, s64
    v_perm_b32 v50, v32, v28, s64
    v_perm_b32 v51, v40, v36, s64
    buffer_store_dwordx4 v[48:51], v9, s[32:35], s62 offen
    s_add_u32 s62, s62, 0x1000
    v_perm_b32 v52, v16, v12, s65
    v_perm_b32 v53, v24, v20, s65
    v_perm_b32 v54, v32, v28, s65
    v_perm_b32 v55, v40, v36, s65
    buffer_store_dwordx4 v[52:55], v9, s[32:35], s62 offen
    s_add_u32 s62, s62, 0x1000
    v_perm_b32 v56, v17, v13, s64
    v_perm_b32 v57, v25, v21, s64
    v_perm_b32 v58, v33, v29, s64
    v_perm_b32 v59, v41, v37, s64
    buffer_store_dwordx4 v[56:59], v9, s[32:35], s62 offen
    s_add_u32 s62, s62, 0x1000
    v_perm_b32 v60, v17, v13, s65
    v_perm_b32 v61, v25, v21, s65
    v_perm_b32 v62, v33, v29, s65
    v_perm_b32 v63, v41, v37, s65
    buffer_store_dwordx4 v[60:63], v9, s[32:35], s62 offen
    s_add_u32 s62, s62, 0x1000
    v_perm_b32 v64, v18, v14, s64
    v_perm_b32 v65, v26, v22, s64
    v_perm_b32 v66, v34, v30, s64
    v_perm_b32 v67, v42, v38, s64
    buffer_store_dwordx4 v[64:67], v9, s[32:35], s62 offen
    s_add_u32 s62, s62, 0x1000
    v_perm_b32 v68, v18, v14, s65
    v_perm_b32 v69, v26, v22, s65
    v_perm_b32 v70, v34, v30, s65
    v_perm_b32 v71, v42, v38, s65
    buffer_store_dwordx4 v[68:71], v9, s[32:35], s62 offen
    s_add_u32 s62, s62, 0x1000
    v_perm_b32 v72, v19, v15, s64
    v_perm_b32 v73, v27, v23, s64
    v_perm_b32 v74, v35, v31, s64
    v_perm_b32 v75, v43, v39, s64
    buffer_store_dwordx4 v[72:75], v9, s[32:35], s62 offen
    s_add_u32 s62, s62, 0x1000
    v_perm_b32 v76, v19, v15, s65
    v_perm_b32 v77, v27, v23, s65
    v_perm_b32 v78, v35, v31, s65
    v_perm_b32 v79, v43, v39, s65
    buffer_store_dwordx4 v[76:79], v9, s[32:35], s62 offen
    s_add_u32 s62, s62, 0x1000
    s_branch K1_END
K1_WRBF:
    buffer_load_dwordx4 v[12:15], v9, s[44:47], 0 offen offset:0
    buffer_load_dwordx4 v[16:19], v9, s[44:47], 0 offen offset:768
    buffer_load_dwordx4 v[20:23], v9, s[44:47], 0 offen offset:1536
    buffer_load_dwordx4 v[24:27], v9, s[44:47], 0 offen offset:2304
    v_lshlrev_b32 v10, 10, v8
    v_lshl_add_u32 v10, v7, 3, v10
    s_mov_b32 s62, 98304
    s_mov_b32 exec_hi, 0xffff
    s_waitcnt vmcnt(0)
    v_perm_b32 v48, v16, v12, s64
    v_perm_b32 v49, v24, v20, s64
    buffer_store_dwordx2 v[48:49], v10, s[32:35], s62 offen offset:0
    v_perm_b32 v50, v16, v12, s65
    v_perm_b32 v51, v24, v20, s65
    buffer_store_dwordx2 v[50:51], v10, s[32:35], s62 offen offset:128
    v_perm_b32 v52, v17, v13, s64
    v_perm_b32 v53, v25, v21, s64
    buffer_store_dwordx2 v[52:53], v10, s[32:35], s62 offen offset:256
    v_perm_b32 v54, v17, v13, s65
    v_perm_b32 v55, v25, v21, s65
    buffer_store_dwordx2 v[54:55], v10, s[32:35], s62 offen offset:384
    v_perm_b32 v56, v18, v14, s64
    v_perm_b32 v57, v26, v22, s64
    buffer_store_dwordx2 v[56:57], v10, s[32:35], s62 offen offset:512
    v_perm_b32 v58, v18, v14, s65
    v_perm_b32 v59, v26, v22, s65
    buffer_store_dwordx2 v[58:59], v10, s[32:35], s62 offen offset:640
    v_perm_b32 v60, v19, v15, s64
    v_perm_b32 v61, v27, v23, s64
    buffer_store_dwordx2 v[60:61], v10, s[32:35], s62 offen offset:768
    v_perm_b32 v62, v19, v15, s65
    v_perm_b32 v63, v27, v23, s65
    buffer_store_dwordx2 v[62:63], v10, s[32:35], s62 offen offset:896
    s_branch K1_END
K1_HROLE2:
    s_add_u32 s73, s73, 3
K1_HROLE:
    s_mov_b32 s38, 32768
    s_mov_b32 s39, s27
    s_mov_b32 s86, 25600000
    s_mov_b32 s87, s27
    v_and_b32 v7, 15, v0
    v_bfe_u32 v8, v0, 4, 2
    s_mov_b32 s64, 0x05040100
    s_mov_b32 s65, 0x07060302
    s_cmp_ge_u32 s3, 4
    s_cbranch_scc1 K1_NOW1
    v_lshlrev_b32 v10, 11, v8
    v_lshl_add_u32 v10, v7, 4, v10
    s_lshl_b32 s59, s3, 13
    s_waitcnt lgkmcnt(0)
    buffer_load_dwordx4 v[56:59], v10, s[36:39], s59 offen offset:0
    buffer_load_dwordx4 v[60:63], v10, s[36:39], s59 offen offset:256
    buffer_load_dwordx4 v[64:67], v10, s[36:39], s59 offen offset:512
    buffer_load_dwordx4 v[68:71], v10, s[36:39], s59 offen offset:768
    buffer_load_dwordx4 v[72:75], v10, s[36:39], s59 offen offset:1024
    buffer_load_dwordx4 v[76:79], v10, s[36:39], s59 offen offset:1280
    buffer_load_dwordx4 v[80:83], v10, s[36:39], s59 offen offset:1536
    buffer_load_dwordx4 v[84:87], v10, s[36:39], s59 offen offset:1792
    s_getpc_b64 s[60:61]
K1_PCH:
    s_sub_u32 s60, s60, K1_PCH-edge_bin_kernel
    s_subb_u32 s61, s61, 0
    v_lshlrev_b32 v12, 7, v0
    v_min_u32 v12, K2_END-edge_bin_kernel, v12
    global_load_dword v121, v12, s[60:61]
    s_lshl_b32 s59, s3, 10
    v_add_u32 v28, s59, v9
    s_load_dwordx2 s[32:33], s[0:1], 80
    s_load_dwordx2 s[10:11], s[0:1], 32
    s_load_dwordx2 s[40:41], s[0:1], 48
    s_load_dwordx2 s[44:45], s[0:1], 56
    s_mov_b32 s52, 0xffff0000
    s_mov_b32 s86, 25600000
    s_mov_b32 s87, s27
    s_mov_b32 s34, 33554432
    s_mov_b32 s35, s27
    s_mov_b32 s42, 98304
    s_mov_b32 s43, s27
    s_mov_b32 s46, 3072
    s_mov_b32 s47, s27
    s_mov_b32 s90, 6400000
    s_mov_b32 s91, s27
    s_waitcnt lgkmcnt(0)
    s_add_u32 s88, s32, 14680064
    s_addc_u32 s89, s33, 0
    s_waitcnt vmcnt(1)
    v_perm_b32 v88, v60, v56, s64
    v_perm_b32 v89, v68, v64, s64
    v_perm_b32 v90, v76, v72, s64
    v_perm_b32 v91, v84, v80, s64
    ds_write_b128 v28, v[88:91] offset:0
    v_perm_b32 v92, v60, v56, s65
    v_perm_b32 v93, v68, v64, s65
    v_perm_b32 v94, v76, v72, s65
    v_perm_b32 v95, v84, v80, s65
    ds_write_b128 v28, v[92:95] offset:4096
    v_perm_b32 v96, v61, v57, s64
    v_perm_b32 v97, v69, v65, s64
    v_perm_b32 v98, v77, v73, s64
    v_perm_b32 v99, v85, v81, s64
    ds_write_b128 v28, v[96:99] offset:8192
    v_perm_b32 v100, v61, v57, s65
    v_perm_b32 v101, v69, v65, s65
    v_perm_b32 v102, v77, v73, s65
    v_perm_b32 v103, v85, v81, s65
    ds_write_b128 v28, v[100:103] offset:12288
    v_perm_b32 v104, v62, v58, s64
    v_perm_b32 v105, v70, v66, s64
    v_perm_b32 v106, v78, v74, s64
    v_perm_b32 v107, v86, v82, s64
    ds_write_b128 v28, v[104:107] offset:16384
    v_perm_b32 v108, v62, v58, s65
    v_perm_b32 v109, v70, v66, s65
    v_perm_b32 v110, v78, v74, s65
    v_perm_b32 v111, v86, v82, s65
    ds_write_b128 v28, v[108:111] offset:20480
    v_perm_b32 v112, v63, v59, s64
    v_perm_b32 v113, v71, v67, s64
    v_perm_b32 v114, v79, v75, s64
    v_perm_b32 v115, v87, v83, s64
    ds_write_b128 v28, v[112:115] offset:24576
    v_perm_b32 v116, v63, v59, s65
    v_perm_b32 v117, v71, v67, s65
    v_perm_b32 v118, v79, v75, s65
    v_perm_b32 v119, v87, v83, s65
    ds_write_b128 v28, v[116:119] offset:28672
    s_waitcnt lgkmcnt(0)
    s_barrier
    s_cmp_eq_u32 s3, 1
    s_cbranch_scc1 K1_TLB
    s_cmp_lg_u32 s3, 0
    s_cbranch_scc1 K1_FIN
    s_mov_b32 s74, s73
    s_cmp_le_u32 s74, 12
    s_cbranch_scc1 K1_WJOB
    s_branch K1_FIN
K1_TLB:
    s_load_dwordx2 s[60:61], s[0:1], 64
    v_lshlrev_b32 v12, 19, v6
    buffer_load_dword v13, v12, s[84:87], 0 offen
    s_waitcnt lgkmcnt(0)
    s_mov_b32 s62, 25600000
    s_mov_b32 s63, 0x00020000
    buffer_load_dword v15, v12, s[60:63], 0 offen
    s_branch K1_FIN
K1_NOW1:
    s_mul_i32 s57, s73, 12
    s_add_u32 s57, s57, s3
    s_sub_u32 s57, s57, 4
    s_lshl_b32 s57, s57, 4
    s_lshl_b32 s58, s57, 10
    v_lshlrev_b32 v11, 10, v7
    v_lshl_add_u32 v11, v8, 4, v11
    s_load_dwordx2 s[32:33], s[0:1], 80
    s_load_dwordx2 s[10:11], s[0:1], 32
    s_load_dwordx2 s[40:41], s[0:1], 48
    s_load_dwordx2 s[44:45], s[0:1], 56
    s_mov_b32 s52, 0xffff0000
    s_mov_b32 s86, 25600000
    s_mov_b32 s87, s27
    s_mov_b32 s34, 33554432
    s_mov_b32 s35, s27
    s_mov_b32 s42, 98304
    s_mov_b32 s43, s27
    s_mov_b32 s46, 3072
    s_mov_b32 s47, s27
    s_mov_b32 s90, 6400000
    s_mov_b32 s91, s27
    s_waitcnt lgkmcnt(0)
    s_add_u32 s88, s32, 14680064
    s_addc_u32 s89, s33, 0
    buffer_load_dwordx4 v[40:43], v11, s[84:87], s58 offen offset:0
    buffer_load_dwordx4 v[44:47], v11, s[84:87], s58 offen offset:64
    buffer_load_dwordx4 v[48:51], v11, s[84:87], s58 offen offset:128
    buffer_load_dwordx4 v[52:55], v11, s[84:87], s58 offen offset:192
    s_barrier
    s_cmp_ge_u32 s57, 25000
    s_cbranch_scc1 K1_FIN
    ds_read_b128 v[56:59], v9 offset:0
    ds_read_b128 v[60:63], v9 offset:1024
    ds_read_b128 v[64:67], v9 offset:2048
    ds_read_b128 v[68:71], v9 offset:3072
    v_lshlrev_b32 v30, 10, v8
    v_lshl_add_u32 v30, v7, 4, v30
    s_lshl_b32 s58, s57, 8
    s_waitcnt vmcnt(0)
    s_waitcnt lgkmcnt(3)
    v_mfma_f32_16x16x32_bf16 v[72:75], v[40:43], v[56:59], 0
    ds_read_b128 v[56:59], v9 offset:4096
    s_waitcnt lgkmcnt(3)
    v_mfma_f32_16x16x32_bf16 v[72:75], v[44:47], v[60:63], v[72:75]
    ds_read_b128 v[60:63], v9 offset:5120
    s_waitcnt lgkmcnt(3)
    v_mfma_f32_16x16x32_bf16 v[72:75], v[48:51], v[64:67], v[72:75]
    ds_read_b128 v[64:67], v9 offset:6144
    s_waitcnt lgkmcnt(3)
    v_mfma_f32_16x16x32_bf16 v[72:75], v[52:55], v[68:71], v[72:75]
    ds_read_b128 v[68:71], v9 offset:7168
    s_nop 6
    v_mul_f32 v12, 0xbfb8aa3b, v72
    v_mul_f32 v13, 0xbfb8aa3b, v73
    v_mul_f32 v14, 0xbfb8aa3b, v74
    v_mul_f32 v15, 0xbfb8aa3b, v75
    v_exp_f32 v12, v12
    v_exp_f32 v13, v13
    s_waitcnt lgkmcnt(3)
    v_mfma_f32_16x16x32_bf16 v[76:79], v[40:43], v[56:59], 0
    ds_read_b128 v[56:59], v9 offset:8192
    v_exp_f32 v14, v14
    s_waitcnt lgkmcnt(3)
    v_mfma_f32_16x16x32_bf16 v[76:79], v[44:47], v[60:63], v[76:79]
    ds_read_b128 v[60:63], v9 offset:9216
    v_exp_f32 v15, v15
    s_waitcnt lgkmcnt(3)
    v_mfma_f32_16x16x32_bf16 v[76:79], v[48:51], v[64:67], v[76:79]
    ds_read_b128 v[64:67], v9 offset:10240
    v_add_f32 v12, 1.0, v12
    s_waitcnt lgkmcnt(3)
    v_mfma_f32_16x16x32_bf16 v[76:79], v[52:55], v[68:71], v[76:79]
    ds_read_b128 v[68:71], v9 offset:11264
    v_add_f32 v13, 1.0, v13
    v_add_f32 v14, 1.0, v14
    v_add_f32 v15, 1.0, v15
    v_rcp_f32 v12, v12
    v_rcp_f32 v13, v13
    s_nop 1
    v_mul_f32 v16, 0xbfb8aa3b, v76
    v_mul_f32 v17, 0xbfb8aa3b, v77
    v_mul_f32 v18, 0xbfb8aa3b, v78
    v_mul_f32 v19, 0xbfb8aa3b, v79
    v_exp_f32 v16, v16
    s_waitcnt lgkmcnt(3)
    v_mfma_f32_16x16x32_bf16 v[80:83], v[40:43], v[56:59], 0
    ds_read_b128 v[56:59], v9 offset:12288
    v_exp_f32 v17, v17
    s_waitcnt lgkmcnt(3)
    v_mfma_f32_16x16x32_bf16 v[80:83], v[44:47], v[60:63], v[80:83]
    ds_read_b128 v[60:63], v9 offset:13312
    v_exp_f32 v18, v18
    s_waitcnt lgkmcnt(3)
    v_mfma_f32_16x16x32_bf16 v[80:83], v[48:51], v[64:67], v[80:83]
    ds_read_b128 v[64:67], v9 offset:14336
    v_exp_f32 v19, v19
    s_waitcnt lgkmcnt(3)
    v_mfma_f32_16x16x32_bf16 v[80:83], v[52:55], v[68:71], v[80:83]
    ds_read_b128 v[68:71], v9 offset:15360
    v_add_f32 v16, 1.0, v16
    v_add_f32 v17, 1.0, v17
    v_add_f32 v18, 1.0, v18
    v_add_f32 v19, 1.0, v19
    v_rcp_f32 v16, v16
    v_rcp_f32 v17, v17
    s_nop 0
    v_mul_f32 v20, 0xbfb8aa3b, v80
    v_mul_f32 v21, 0xbfb8aa3b, v81
    v_mul_f32 v22, 0xbfb8aa3b, v82
    v_mul_f32 v23, 0xbfb8aa3b, v83
    s_waitcnt lgkmcnt(3)
    v_mfma_f32_16x16x32_bf16 v[84:87], v[40:43], v[56:59], 0
    ds_read_b128 v[56:59], v9 offset:16384
    v_exp_f32 v20, v20
    s_waitcnt lgkmcnt(3)
    v_mfma_f32_16x16x32_bf16 v[84:87], v[44:47], v[60:63], v[84:87]
    ds_read_b128 v[60:63], v9 offset:17408
    v_exp_f32 v21, v21
    s_waitcnt lgkmcnt(3)
    v_mfma_f32_16x16x32_bf16 v[84:87], v[48:51], v[64:67], v[84:87]
    ds_read_b128 v[64:67], v9 offset:18432
    v_exp_f32 v22, v22
    s_waitcnt lgkmcnt(3)
    v_mfma_f32_16x16x32_bf16 v[84:87], v[52:55], v[68:71], v[84:87]
    ds_read_b128 v[68:71], v9 offset:19456
    v_exp_f32 v23, v23
    v_add_f32 v20, 1.0, v20
    v_add_f32 v21, 1.0, v21
    v_add_f32 v22, 1.0, v22
    v_add_f32 v23, 1.0, v23
    v_rcp_f32 v20, v20
    s_nop 0
    v_mul_f32 v24, 0xbfb8aa3b, v84
    v_mul_f32 v25, 0xbfb8aa3b, v85
    v_mul_f32 v26, 0xbfb8aa3b, v86
    v_mul_f32 v27, 0xbfb8aa3b, v87
    s_waitcnt lgkmcnt(3)
    v_mfma_f32_16x16x32_bf16 v[88:91], v[40:43], v[56:59], 0
    ds_read_b128 v[56:59], v9 offset:20480
    v_exp_f32 v24, v24
    s_waitcnt lgkmcnt(3)
    v_mfma_f32_16x16x32_bf16 v[88:91], v[44:47], v[60:63], v[88:91]
    ds_read_b128 v[60:63], v9 offset:21504
    v_exp_f32 v25, v25
    s_waitcnt lgkmcnt(3)
    v_mfma_f32_16x16x32_bf16 v[88:91], v[48:51], v[64:67], v[88:91]
    ds_read_b128 v[64:67], v9 offset:22528
    v_exp_f32 v26, v26
    s_waitcnt lgkmcnt(3)
    v_mfma_f32_16x16x32_bf16 v[88:91], v[52:55], v[68:71], v[88:91]
    ds_read_b128 v[68:71], v9 offset:23552
    v_exp_f32 v27, v27
    v_add_f32 v24, 1.0, v24
    v_add_f32 v25, 1.0, v25
    v_add_f32 v26, 1.0, v26
    v_add_f32 v27, 1.0, v27
    v_rcp_f32 v24, v24
    v_rcp_f32 v21, v21
    v_rcp_f32 v25, v25
    s_waitcnt lgkmcnt(3)
    v_mfma_f32_16x16x32_bf16 v[92:95], v[40:43], v[56:59], 0
    ds_read_b128 v[56:59], v9 offset:24576
    v_rcp_f32 v14, v14
    s_waitcnt lgkmcnt(3)
    v_mfma_f32_16x16x32_bf16 v[92:95], v[44:47], v[60:63], v[92:95]
    ds_read_b128 v[60:63], v9 offset:25600
    v_rcp_f32 v18, v18
    s_waitcnt lgkmcnt(3)
    v_mfma_f32_16x16x32_bf16 v[92:95], v[48:51], v[64:67], v[92:95]
    ds_read_b128 v[64:67], v9 offset:26624
    v_rcp_f32 v22, v22
    s_waitcnt lgkmcnt(3)
    v_mfma_f32_16x16x32_bf16 v[92:95], v[52:55], v[68:71], v[92:95]
    ds_read_b128 v[68:71], v9 offset:27648
    v_rcp_f32 v26, v26
    v_rcp_f32 v15, v15
    v_rcp_f32 v19, v19
    v_rcp_f32 v23, v23
    v_rcp_f32 v27, v27
    v_mul_f32 v72, v72, v12
    v_mul_f32 v76, v76, v16
    s_waitcnt lgkmcnt(3)
    v_mfma_f32_16x16x32_bf16 v[96:99], v[40:43], v[56:59], 0
    ds_read_b128 v[56:59], v9 offset:28672
    v_mul_f32 v80, v80, v20
    v_mul_f32 v84, v84, v24
    s_waitcnt lgkmcnt(3)
    v_mfma_f32_16x16x32_bf16 v[96:99], v[44:47], v[60:63], v[96:99]
    ds_read_b128 v[60:63], v9 offset:29696
    v_mul_f32 v73, v73, v13
    v_mul_f32 v77, v77, v17
    s_waitcnt lgkmcnt(3)
    v_mfma_f32_16x16x32_bf16 v[96:99], v[48:51], v[64:67], v[96:99]
    ds_read_b128 v[64:67], v9 offset:30720
    v_mul_f32 v81, v81, v21
    v_mul_f32 v85, v85, v25
    s_waitcnt lgkmcnt(3)
    v_mfma_f32_16x16x32_bf16 v[96:99], v[52:55], v[68:71], v[96:99]
    ds_read_b128 v[68:71], v9 offset:31744
    v_mul_f32 v74, v74, v14
    v_mul_f32 v78, v78, v18
    v_mul_f32 v82, v82, v22
    v_mul_f32 v86, v86, v26
    v_mul_f32 v75, v75, v15
    v_mul_f32 v79, v79, v19
    v_mul_f32 v83, v83, v23
    v_mul_f32 v87, v87, v27
    v_mul_f32 v12, 0xbfb8aa3b, v88
    v_mul_f32 v16, 0xbfb8aa3b, v92
    v_mul_f32 v20, 0xbfb8aa3b, v96
    v_mul_f32 v13, 0xbfb8aa3b, v89
    s_waitcnt lgkmcnt(3)
    v_mfma_f32_16x16x32_bf16 v[100:103], v[40:43], v[56:59], 0
    v_mul_f32 v17, 0xbfb8aa3b, v93
    v_mul_f32 v21, 0xbfb8aa3b, v97
    v_mul_f32 v14, 0xbfb8aa3b, v90
    s_waitcnt lgkmcnt(2)
    v_mfma_f32_16x16x32_bf16 v[100:103], v[44:47], v[60:63], v[100:103]
    v_mul_f32 v18, 0xbfb8aa3b, v94
    v_mul_f32 v22, 0xbfb8aa3b, v98
    v_mul_f32 v15, 0xbfb8aa3b, v91
    s_waitcnt lgkmcnt(1)
    v_mfma_f32_16x16x32_bf16 v[100:103], v[48:51], v[64:67], v[100:103]
    v_mul_f32 v19, 0xbfb8aa3b, v95
    v_mul_f32 v23, 0xbfb8aa3b, v99
    v_exp_f32 v12, v12
    s_waitcnt lgkmcnt(0)
    v_mfma_f32_16x16x32_bf16 v[100:103], v[52:55], v[68:71], v[100:103]
    v_exp_f32 v16, v16
    v_exp_f32 v20, v20
    v_exp_f32 v13, v13
    v_exp_f32 v17, v17
    s_nop 3
    v_mul_f32 v24, 0xbfb8aa3b, v100
    v_mul_f32 v25, 0xbfb8aa3b, v101
    v_mul_f32 v26, 0xbfb8aa3b, v102
    v_mul_f32 v27, 0xbfb8aa3b, v103
    v_exp_f32 v24, v24
    v_exp_f32 v21, v21
    v_exp_f32 v25, v25
    v_exp_f32 v14, v14
    v_exp_f32 v18, v18
    v_exp_f32 v22, v22
    v_exp_f32 v26, v26
    v_exp_f32 v15, v15
    v_exp_f32 v19, v19
    v_exp_f32 v23, v23
    v_exp_f32 v27, v27
    v_add_f32 v12, 1.0, v12
    v_add_f32 v16, 1.0, v16
    v_add_f32 v20, 1.0, v20
    v_add_f32 v24, 1.0, v24
    v_add_f32 v13, 1.0, v13
    v_add_f32 v17, 1.0, v17
    v_add_f32 v21, 1.0, v21
    v_add_f32 v25, 1.0, v25
    v_add_f32 v14, 1.0, v14
    v_add_f32 v18, 1.0, v18
    v_add_f32 v22, 1.0, v22
    v_add_f32 v26, 1.0, v26
    v_add_f32 v15, 1.0, v15
    v_add_f32 v19, 1.0, v19
    v_add_f32 v23, 1.0, v23
    v_add_f32 v27, 1.0, v27
    v_rcp_f32 v12, v12
    v_rcp_f32 v16, v16
    v_rcp_f32 v20, v20
    v_rcp_f32 v24, v24
    v_rcp_f32 v13, v13
    v_rcp_f32 v17, v17
    v_rcp_f32 v21, v21
    v_rcp_f32 v25, v25
    v_rcp_f32 v14, v14
    v_rcp_f32 v18, v18
    v_rcp_f32 v22, v22
    v_rcp_f32 v26, v26
    v_rcp_f32 v15, v15
    v_rcp_f32 v19, v19
    v_rcp_f32 v23, v23
    v_rcp_f32 v27, v27
    v_mul_f32 v88, v88, v12
    v_mul_f32 v92, v92, v16
    v_mul_f32 v96, v96, v20
    v_mul_f32 v100, v100, v24
    v_mul_f32 v89, v89, v13
    v_mul_f32 v93, v93, v17
    v_mul_f32 v97, v97, v21
    v_mul_f32 v101, v101, v25
    v_mul_f32 v90, v90, v14
    v_mul_f32 v94, v94, v18
    v_mul_f32 v98, v98, v22
    v_mul_f32 v102, v102, v26
    v_mul_f32 v91, v91, v15
    v_mul_f32 v95, v95, v19
    v_mul_f32 v99, v99, v23
    v_mul_f32 v103, v103, v27
    v_cvt_pk_bf16_f32 v104, v72, v76
    v_cvt_pk_bf16_f32 v105, v80, v84
    v_cvt_pk_bf16_f32 v106, v88, v92
    v_cvt_pk_bf16_f32 v107, v96, v100
    v_cvt_pk_bf16_f32 v108, v73, v77
    v_cvt_pk_bf16_f32 v109, v81, v85
    v_cvt_pk_bf16_f32 v110, v89, v93
    v_cvt_pk_bf16_f32 v111, v97, v101
    v_cvt_pk_bf16_f32 v112, v74, v78
    v_cvt_pk_bf16_f32 v113, v82, v86
    v_cvt_pk_bf16_f32 v114, v90, v94
    v_cvt_pk_bf16_f32 v115, v98, v102
    v_cvt_pk_bf16_f32 v116, v75, v79
    v_cvt_pk_bf16_f32 v117, v83, v87
    v_cvt_pk_bf16_f32 v118, v91, v95
    v_cvt_pk_bf16_f32 v119, v99, v103
    buffer_store_dwordx4 v[104:107], v30, s[88:91], s58 offen offset:0 sc1
    buffer_store_dwordx4 v[108:111], v30, s[88:91], s58 offen offset:256 sc1
    buffer_store_dwordx4 v[112:115], v30, s[88:91], s58 offen offset:512 sc1
    buffer_store_dwordx4 v[116:119], v30, s[88:91], s58 offen offset:768 sc1
    s_nop 1
K1_FIN:
K1_END:
    s_endpgm
.globl message_kernel
.p2align 8
.type message_kernel,@function
message_kernel:
    s_cmp_ge_u32 s2, 256
    s_cbranch_scc1 K2_END
    s_load_dwordx2 s[20:21], s[0:1], 80
    s_load_dwordx2 s[4:5], s[0:1], 0
    s_load_dwordx2 s[6:7], s[0:1], 64
    v_lshrrev_b32 v32, 6, v0
    v_mov_b32 v18, 0x40000000
    v_readfirstlane_b32 s3, v32
    s_mov_b32 s22, 33554432
    s_mov_b32 s23, 0x00020000
    v_lshrrev_b32 v33, 1, v0
    v_lshlrev_b32 v33, 10, v33
    v_cmp_gt_u32 vcc, 250, v0
    s_nop 1
    v_cndmask_b32 v33, v18, v33, vcc
    s_lshl_b32 s48, s2, 2
    s_add_u32 s48, s48, 262144
    v_and_b32 v1, 63, v0
    v_lshlrev_b32 v2, 4, v1
    s_sub_u32 s49, s3, 4
    s_lshl_b32 s91, s49, 10
    s_cmp_ge_u32 s3, 4
    s_cbranch_scc1 K2_W0
    s_waitcnt lgkmcnt(0)
    buffer_load_dword v34, v33, s[20:23], s48 offen
    s_mov_b32 s1, 0
    s_branch K2_INIT
K2_W0:
    s_lshr_b32 s84, s2, 3
    s_mul_i32 s84, s84, 25
    s_lshr_b32 s84, s84, 5
    s_lshl_b32 s84, s84, 2
    s_add_u32 s84, s84, s49
    s_lshl_b32 m0, s84, 10
    s_waitcnt lgkmcnt(0)
    buffer_load_dwordx4 v2, s[20:23], m0 offen lds
    s_add_u32 m0, m0, 0x1000
    s_cmp_ge_u32 m0, 102400
    s_cselect_b32 m0, s91, m0
    s_nop 0
    buffer_load_dwordx4 v2, s[20:23], m0 offen lds
    s_add_u32 m0, m0, 0x1000
    s_cmp_ge_u32 m0, 102400
    s_cselect_b32 m0, s91, m0
    s_nop 0
    buffer_load_dwordx4 v2, s[20:23], m0 offen lds
    s_add_u32 m0, m0, 0x1000
    s_cmp_ge_u32 m0, 102400
    s_cselect_b32 m0, s91, m0
    s_nop 0
    buffer_load_dwordx4 v2, s[20:23], m0 offen lds
    s_add_u32 m0, m0, 0x1000
    s_cmp_ge_u32 m0, 102400
    s_cselect_b32 m0, s91, m0
    s_nop 0
    buffer_load_dwordx4 v2, s[20:23], m0 offen lds
    s_add_u32 m0, m0, 0x1000
    s_cmp_ge_u32 m0, 102400
    s_cselect_b32 m0, s91, m0
    s_nop 0
    buffer_load_dwordx4 v2, s[20:23], m0 offen lds
    s_add_u32 m0, m0, 0x1000
    s_cmp_ge_u32 m0, 102400
    s_cselect_b32 m0, s91, m0
    s_nop 0
    buffer_load_dwordx4 v2, s[20:23], m0 offen lds
    s_add_u32 m0, m0, 0x1000
    s_cmp_ge_u32 m0, 102400
    s_cselect_b32 m0, s91, m0
    s_nop 0
    buffer_load_dwordx4 v2, s[20:23], m0 offen lds
    s_add_u32 m0, m0, 0x1000
    s_cmp_ge_u32 m0, 102400
    s_cselect_b32 m0, s91, m0
    s_mov_b32 s1, 1
K2_INIT:
    s_mul_i32 s29, s2, 3125
    s_add_u32 s30, s29, 3156
    s_add_u32 s29, s29, 31
    s_lshr_b32 s29, s29, 5
    s_lshr_b32 s30, s30, 5
    s_sub_u32 s30, s30, s29
    s_sub_u32 s100, s30, 44
    s_mov_b32 s31, 0
    s_mov_b32 s32, 8
    s_mov_b32 s34, 0
    s_mov_b32 s8, s20
    s_mov_b32 s9, s21
    v_lshlrev_b32 v36, 2, v0
    v_add_u32 v36, 102400, v36
    v_mov_b32 v37, 0
    v_mov_b32 v38, 103488
    v_cmp_gt_u32 vcc, 0x80, v0
    s_nop 0
    s_and_saveexec_b64 s[60:61], vcc
    ds_write_b32 v36, v37
    ds_write_b32 v38, v37
    ds_write_b32 v38, v37 offset:8
    s_mov_b64 exec, -1
    s_mov_b32 s12, s4
    s_mov_b32 s13, s5
    s_mov_b32 s14, 25600000
    s_mov_b32 s15, 0x00020000
    s_mov_b32 s16, s6
    s_mov_b32 s17, s7
    s_mov_b32 s18, 25600000
    s_mov_b32 s19, 0x00020000
    s_mov_b32 s24, s4
    s_mov_b32 s25, s5
    s_mov_b32 s26, 25600000
    s_mov_b32 s27, 0x00020000
    s_add_u32 s96, s8, 14680064
    s_addc_u32 s97, s9, 0
    s_mov_b32 s98, 6400000
    s_mov_b32 s99, 0x00020000
    v_add_u32 v3, 0x10000, v2
    v_and_b32 v5, 15, v1
    v_lshrrev_b32 v35, 4, v1
    v_lshlrev_b32 v4, 3, v5
    v_add_u32 v4, 98304, v4
    v_lshlrev_b32 v6, 2, v35
    v_lshlrev_b32 v7, 4, v35
    v_lshlrev_b32 v8, 4, v5
    v_lshlrev_b32 v9, 5, v5
    v_add_u32 v9, 103552, v9
    v_lshlrev_b32 v10, 7, v35
    v_add_u32 v10, 103552, v10
    v_and_b32 v36, 1, v35
    v_lshl_add_u32 v11, v36, 3, v9
    v_add_u32 v11, 16, v11
    v_lshlrev_b32 v15, 1, v35
    v_lshl_add_u32 v14, v35, 11, v8
    v_lshrrev_b32 v36, 2, v5
    v_and_b32 v37, 1, v5
    v_lshl_add_u32 v39, v36, 1, v37
    v_and_b32 v40, 2, v5
    v_cmp_eq_u32 vcc, 0, v40
    s_nop 1
    v_cndmask_b32 v12, -1, v39, vcc
    v_cndmask_b32_e64 v13, v39, -1, vcc
    v_lshlrev_b32 v37, 4, v37
    v_mov_b32 v41, 0x3f80
    v_lshlrev_b32 v41, v37, v41
    v_mov_b32 v21, 0xffff0000
    v_mov_b32 v27, 16
    v_cndmask_b32 v30, 0, v41, vcc
    v_cndmask_b32_e64 v31, v41, 0, vcc
    v_cmp_gt_u32_e64 s[56:57], 32, v1
    s_mov_b32 s28, 0xffff0000
    s_mov_b32 s52, 0xffff
    s_mov_b32 s53, 0x3f803f80
    s_mov_b32 s54, 0x05040100
    s_mov_b32 s55, 0x07060302
    s_cmp_lt_u32 s3, 4
    s_waitcnt lgkmcnt(0)
    s_cbranch_scc1 K2_RECSIDE
    s_barrier
    buffer_load_dwordx4 v2, s[20:23], m0 offen lds
    s_add_u32 m0, m0, 0x1000
    s_cmp_ge_u32 m0, 102400
    s_cselect_b32 m0, s91, m0
    s_nop 0
    buffer_load_dwordx4 v2, s[20:23], m0 offen lds
    s_add_u32 m0, m0, 0x1000
    s_cmp_ge_u32 m0, 102400
    s_cselect_b32 m0, s91, m0
    s_nop 0
    buffer_load_dwordx4 v2, s[20:23], m0 offen lds
    s_add_u32 m0, m0, 0x1000
    s_cmp_ge_u32 m0, 102400
    s_cselect_b32 m0, s91, m0
    s_nop 0
    buffer_load_dwordx4 v2, s[20:23], m0 offen lds
    s_add_u32 m0, m0, 0x1000
    s_cmp_ge_u32 m0, 102400
    s_cselect_b32 m0, s91, m0
    s_nop 0
    buffer_load_dwordx4 v2, s[20:23], m0 offen lds
    s_add_u32 m0, m0, 0x1000
    s_cmp_ge_u32 m0, 102400
    s_cselect_b32 m0, s91, m0
    s_nop 0
    buffer_load_dwordx4 v2, s[20:23], m0 offen lds
    s_add_u32 m0, m0, 0x1000
    s_cmp_ge_u32 m0, 102400
    s_cselect_b32 m0, s91, m0
    s_nop 0
    buffer_load_dwordx4 v2, s[20:23], m0 offen lds
    s_add_u32 m0, m0, 0x1000
    s_cmp_ge_u32 m0, 102400
    s_cselect_b32 m0, s91, m0
    s_nop 0
    buffer_load_dwordx4 v2, s[20:23], m0 offen lds
    s_add_u32 m0, m0, 0x1000
    s_cmp_ge_u32 m0, 102400
    s_cselect_b32 m0, s91, m0
    s_nop 0
    buffer_load_dwordx4 v2, s[20:23], m0 offen lds
    s_add_u32 m0, m0, 0x1000
    s_cmp_ge_u32 m0, 102400
    s_cselect_b32 m0, s91, m0
    s_nop 0
    buffer_load_dwordx4 v2, s[20:23], m0 offen lds
    s_add_u32 m0, m0, 0x1000
    s_cmp_ge_u32 m0, 102400
    s_cselect_b32 m0, s91, m0
    s_nop 0
    buffer_load_dwordx4 v2, s[20:23], m0 offen lds
    s_add_u32 m0, m0, 0x1000
    s_cmp_ge_u32 m0, 102400
    s_cselect_b32 m0, s91, m0
    s_nop 0
    buffer_load_dwordx4 v2, s[20:23], m0 offen lds
    s_add_u32 m0, m0, 0x1000
    s_cmp_ge_u32 m0, 102400
    s_cselect_b32 m0, s91, m0
    s_nop 0
    buffer_load_dwordx4 v2, s[20:23], m0 offen lds
    s_add_u32 m0, m0, 0x1000
    s_cmp_ge_u32 m0, 102400
    s_cselect_b32 m0, s91, m0
    s_nop 0
    buffer_load_dwordx4 v2, s[20:23], m0 offen lds
    s_add_u32 m0, m0, 0x1000
    s_cmp_ge_u32 m0, 102400
    s_cselect_b32 m0, s91, m0
    s_nop 0
    buffer_load_dwordx4 v2, s[20:23], m0 offen lds
    s_add_u32 m0, m0, 0x1000
    s_cmp_ge_u32 m0, 102400
    s_cselect_b32 m0, s91, m0
    s_nop 0
    buffer_load_dwordx4 v2, s[20:23], m0 offen lds
    s_add_u32 m0, m0, 0x1000
    s_cmp_ge_u32 m0, 102400
    s_cselect_b32 m0, s91, m0
    s_nop 0
    buffer_load_dwordx4 v2, s[20:23], m0 offen lds
    s_add_u32 m0, m0, 0x1000
    s_cmp_ge_u32 m0, 102400
    s_cselect_b32 m0, s91, m0
    s_lshl_b32 s48, s29, 10
    s_lshl_b32 s50, s91, 3
    s_add_u32 s48, s48, s50
    v_lshlrev_b32 v200, 7, v1
    buffer_load_dword v204, v200, s[12:15], s48 offen
    s_add_u32 s48, s48, 0x8000
    s_barrier
    s_branch K2_AFTER_B1
K2_ROUND:
    s_cmp_lt_u32 s3, 4
    s_cbranch_scc1 K2_RECSIDE
    s_barrier
    s_branch K2_AFTER_REC
K2_RECSIDE:
    v_and_b32 v37, 1, v0
    v_lshrrev_b32 v39, 1, v0
    v_mul_u32_u24 v39, 3200, v39
    s_lshl_b32 s48, s31, 1
    v_add3_u32 v39, v39, v37, s48
    s_mov_b32 s48, 1048576
    s_waitcnt vmcnt(0)
    v_and_b32 v35, 0xffff, v34
    v_lshrrev_b32 v36, 16, v34
    v_add_lshl_u32 v39, v39, v35, 5
    v_sub_u32 v36, v36, v37
    v_add_u32 v36, 1, v36
    v_lshrrev_b32 v36, 1, v36
    v_subrev_u32 v36, s31, v36
    v_max_i32 v36, 0, v36
    v_cmp_lt_u32_e64 s[60:61], s32, v36
    v_min_u32 v36, s32, v36
    v_cmp_lt_u32 vcc, 0, v36
    s_nop 0
    s_and_b64 exec, exec, vcc
    s_nop 1
    s_cbranch_execz K2_REC_ISSUED
    buffer_load_dwordx4 v[64:67], v39, s[20:23], s48 offen offset:0
    buffer_load_dwordx4 v[68:71], v39, s[20:23], s48 offen offset:16
    v_cmp_lt_u32 vcc, 1, v36
    s_nop 0
    s_and_b64 exec, exec, vcc
    s_nop 1
    s_cbranch_execz K2_REC_ISSUED
    buffer_load_dwordx4 v[72:75], v39, s[20:23], s48 offen offset:64
    buffer_load_dwordx4 v[76:79], v39, s[20:23], s48 offen offset:80
    v_cmp_lt_u32 vcc, 2, v36
    s_nop 0
    s_and_b64 exec, exec, vcc
    s_nop 1
    s_cbranch_execz K2_REC_ISSUED
    buffer_load_dwordx4 v[80:83], v39, s[20:23], s48 offen offset:128
    buffer_load_dwordx4 v[84:87], v39, s[20:23], s48 offen offset:144
    v_cmp_lt_u32 vcc, 3, v36
    s_nop 0
    s_and_b64 exec, exec, vcc
    s_nop 1
    s_cbranch_execz K2_REC_ISSUED
    buffer_load_dwordx4 v[88:91], v39, s[20:23], s48 offen offset:192
    buffer_load_dwordx4 v[92:95], v39, s[20:23], s48 offen offset:208
    v_cmp_lt_u32 vcc, 4, v36
    s_nop 0
    s_and_b64 exec, exec, vcc
    s_nop 1
    s_cbranch_execz K2_REC_ISSUED
    buffer_load_dwordx4 v[96:99], v39, s[20:23], s48 offen offset:256
    buffer_load_dwordx4 v[100:103], v39, s[20:23], s48 offen offset:272
    v_cmp_lt_u32 vcc, 5, v36
    s_nop 0
    s_and_b64 exec, exec, vcc
    s_nop 1
    s_cbranch_execz K2_REC_ISSUED
    buffer_load_dwordx4 v[104:107], v39, s[20:23], s48 offen offset:320
    buffer_load_dwordx4 v[108:111], v39, s[20:23], s48 offen offset:336
    v_cmp_lt_u32 vcc, 6, v36
    s_nop 0
    s_and_b64 exec, exec, vcc
    s_nop 1
    s_cbranch_execz K2_REC_ISSUED
    buffer_load_dwordx4 v[112:115], v39, s[20:23], s48 offen offset:384
    buffer_load_dwordx4 v[116:119], v39, s[20:23], s48 offen offset:400
    v_cmp_lt_u32 vcc, 7, v36
    s_nop 0
    s_and_b64 exec, exec, vcc
    s_nop 1
    s_cbranch_execz K2_REC_ISSUED
    buffer_load_dwordx4 v[120:123], v39, s[20:23], s48 offen offset:448
    buffer_load_dwordx4 v[124:127], v39, s[20:23], s48 offen offset:464
K2_REC_ISSUED:
    s_mov_b64 exec, -1
    s_barrier
    v_mov_b32 v37, 1
    v_mov_b32 v38, 103488
    s_mov_b64 exec, s[60:61]
    ds_write_b32 v38, v37
    s_mov_b64 exec, -1
    s_mov_b32 s48, 102400
    s_waitcnt vmcnt(0) lgkmcnt(0)
    v_cmp_lt_u32 vcc, 0, v36
    s_nop 0
    s_and_b64 exec, exec, vcc
    s_nop 1
    s_cbranch_execz K2_AFTER_REC
    v_lshl_add_u32 v48, v65, 2, s48
    ds_add_rtn_u32 v40, v48, v37
    v_cmp_lt_u32 vcc, 1, v36
    s_nop 0
    s_and_b64 exec, exec, vcc
    s_nop 1
    s_cbranch_execz K2_AFTER_REC
    v_lshl_add_u32 v49, v73, 2, s48
    ds_add_rtn_u32 v41, v49, v37
    v_cmp_lt_u32 vcc, 2, v36
    s_nop 0
    s_and_b64 exec, exec, vcc
    s_nop 1
    s_cbranch_execz K2_AFTER_REC
    v_lshl_add_u32 v50, v81, 2, s48
    ds_add_rtn_u32 v42, v50, v37
    v_cmp_lt_u32 vcc, 3, v36
    s_nop 0
    s_and_b64 exec, exec, vcc
    s_nop 1
    s_cbranch_execz K2_AFTER_REC
    v_lshl_add_u32 v51, v89, 2, s48
    ds_add_rtn_u32 v43, v51, v37
    v_cmp_lt_u32 vcc, 4, v36
    s_nop 0
    s_and_b64 exec, exec, vcc
    s_nop 1
    s_cbranch_execz K2_AFTER_REC
    v_lshl_add_u32 v52, v97, 2, s48
    ds_add_rtn_u32 v44, v52, v37
    v_cmp_lt_u32 vcc, 5, v36
    s_nop 0
    s_and_b64 exec, exec, vcc
    s_nop 1
    s_cbranch_execz K2_AFTER_REC
    v_lshl_add_u32 v53, v105, 2, s48
    ds_add_rtn_u32 v45, v53, v37
    v_cmp_lt_u32 vcc, 6, v36
    s_nop 0
    s_and_b64 exec, exec, vcc
    s_nop 1
    s_cbranch_execz K2_AFTER_REC
    v_lshl_add_u32 v54, v113, 2, s48
    ds_add_rtn_u32 v46, v54, v37
    v_cmp_lt_u32 vcc, 7, v36
    s_nop 0
    s_and_b64 exec, exec, vcc
    s_nop 1
    s_cbranch_execz K2_AFTER_REC
    v_lshl_add_u32 v55, v121, 2, s48
    ds_add_rtn_u32 v47, v55, v37
    s_nop 0
K2_AFTER_REC:
    s_mov_b64 exec, -1
    s_waitcnt lgkmcnt(0)
    s_barrier
K2_AFTER_B1:
    v_lshlrev_b32 v176, 3, v1
    v_add_u32 v176, 102400, v176
    v_mov_b32 v177, 103488
    ds_read_b32 v177, v177
    ds_read_b64 v[178:179], v176
    s_waitcnt lgkmcnt(0)
    v_add_u32 v180, v178, v179
    v_mov_b32 v181, v180
    s_nop 1
    v_add_u32_dpp v181, v181, v181 row_shr:1 row_mask:0xf bank_mask:0xf bound_ctrl:0
    s_nop 1
    v_add_u32_dpp v181, v181, v181 row_shr:2 row_mask:0xf bank_mask:0xf bound_ctrl:0
    s_nop 1
    v_add_u32_dpp v181, v181, v181 row_shr:4 row_mask:0xf bank_mask:0xf bound_ctrl:0
    s_nop 1
    v_add_u32_dpp v181, v181, v181 row_shr:8 row_mask:0xf bank_mask:0xf bound_ctrl:0
    s_nop 1
    v_add_u32_dpp v181, v181, v181 row_bcast:15 row_mask:0xa bank_mask:0xf
    s_nop 1
    v_add_u32_dpp v181, v181, v181 row_bcast:31 row_mask:0xc bank_mask:0xf
    v_sub_u32 v182, v181, v180
    v_add_u32 v183, v182, v178
    ds_write_b64 v176, v[182:183] offset:512
    v_readlane_b32 s33, v181, 63
    v_readfirstlane_b32 s35, v177
    v_lshl_or_b32 v17, v183, 16, v182
    s_cmp_le_u32 s33, 400
    s_nop 1
    s_cbranch_scc1 K2_FITS
    s_mov_b32 s32, 1
    s_waitcnt lgkmcnt(0)
    s_barrier
    v_lshlrev_b32 v36, 2, v0
    v_add_u32 v36, 102400, v36
    v_mov_b32 v37, 0
    v_mov_b32 v38, 103488
    v_cmp_gt_u32 vcc, 0x80, v0
    s_nop 0
    s_and_saveexec_b64 s[60:61], vcc
    ds_write_b32 v36, v37
    ds_write_b32 v38, v37
    ds_write_b32 v38, v37 offset:8
    s_mov_b64 exec, -1
    s_waitcnt lgkmcnt(0)
    s_branch K2_ROUND
K2_FITS:
    s_cmp_ge_u32 s3, 4
    s_cbranch_scc1 K2_PREAD
    v_cmp_lt_u32 vcc, 0, v36
    s_nop 0
    s_and_b64 exec, exec, vcc
    s_nop 1
    s_cbranch_execz K2_PREAD
    ds_read_b32 v48, v48 offset:512
    v_cmp_lt_u32 vcc, 1, v36
    s_nop 0
    s_and_b64 exec, exec, vcc
    s_nop 1
    s_cbranch_execz K2_PREAD
    ds_read_b32 v49, v49 offset:512
    v_cmp_lt_u32 vcc, 2, v36
    s_nop 0
    s_and_b64 exec, exec, vcc
    s_nop 1
    s_cbranch_execz K2_PREAD
    ds_read_b32 v50, v50 offset:512
    v_cmp_lt_u32 vcc, 3, v36
    s_nop 0
    s_and_b64 exec, exec, vcc
    s_nop 1
    s_cbranch_execz K2_PREAD
    ds_read_b32 v51, v51 offset:512
    v_cmp_lt_u32 vcc, 4, v36
    s_nop 0
    s_and_b64 exec, exec, vcc
    s_nop 1
    s_cbranch_execz K2_PREAD
    ds_read_b32 v52, v52 offset:512
    v_cmp_lt_u32 vcc, 5, v36
    s_nop 0
    s_and_b64 exec, exec, vcc
    s_nop 1
    s_cbranch_execz K2_PREAD
    ds_read_b32 v53, v53 offset:512
    v_cmp_lt_u32 vcc, 6, v36
    s_nop 0
    s_and_b64 exec, exec, vcc
    s_nop 1
    s_cbranch_execz K2_PREAD
    ds_read_b32 v54, v54 offset:512
    v_cmp_lt_u32 vcc, 7, v36
    s_nop 0
    s_and_b64 exec, exec, vcc
    s_nop 1
    s_cbranch_execz K2_PREAD
    ds_read_b32 v55, v55 offset:512
K2_PREAD:
    s_mov_b64 exec, -1
    ds_read_b64 v[184:185], v176 offset:520
    ds_read_b64 v[186:187], v176 offset:528
    ds_read_b64 v[188:189], v176 offset:536
    ds_read_b64 v[190:191], v176 offset:544
    s_waitcnt lgkmcnt(0)
    s_cmp_ge_u32 s3, 4
    s_cbranch_scc1 K2_SCATTERED
    v_cmp_lt_u32 vcc, 0, v36
    s_nop 0
    s_and_b64 exec, exec, vcc
    s_nop 1
    s_cbranch_execz K2_SCATTERED
    v_add_lshl_u32 v48, v48, v40, 5
    v_add_u32 v48, 103552, v48
    ds_write_b128 v48, v[64:67]
    ds_write_b128 v48, v[68:71] offset:16
    v_cmp_lt_u32 vcc, 1, v36
    s_nop 0
    s_and_b64 exec, exec, vcc
    s_nop 1
    s_cbranch_execz K2_SCATTERED
    v_add_lshl_u32 v49, v49, v41, 5
    v_add_u32 v49, 103552, v49
    ds_write_b128 v49, v[72:75]
    ds_write_b128 v49, v[76:79] offset:16
    v_cmp_lt_u32 vcc, 2, v36
    s_nop 0
    s_and_b64 exec, exec, vcc
    s_nop 1
    s_cbranch_execz K2_SCATTERED
    v_add_lshl_u32 v50, v50, v42, 5
    v_add_u32 v50, 103552, v50
    ds_write_b128 v50, v[80:83]
    ds_write_b128 v50, v[84:87] offset:16
    v_cmp_lt_u32 vcc, 3, v36
    s_nop 0
    s_and_b64 exec, exec, vcc
    s_nop 1
    s_cbranch_execz K2_SCATTERED
    v_add_lshl_u32 v51, v51, v43, 5
    v_add_u32 v51, 103552, v51
    ds_write_b128 v51, v[88:91]
    ds_write_b128 v51, v[92:95] offset:16
    v_cmp_lt_u32 vcc, 4, v36
    s_nop 0
    s_and_b64 exec, exec, vcc
    s_nop 1
    s_cbranch_execz K2_SCATTERED
    v_add_lshl_u32 v52, v52, v44, 5
    v_add_u32 v52, 103552, v52
    ds_write_b128 v52, v[96:99]
    ds_write_b128 v52, v[100:103] offset:16
    v_cmp_lt_u32 vcc, 5, v36
    s_nop 0
    s_and_b64 exec, exec, vcc
    s_nop 1
    s_cbranch_execz K2_SCATTERED
    v_add_lshl_u32 v53, v53, v45, 5
    v_add_u32 v53, 103552, v53
    ds_write_b128 v53, v[104:107]
    ds_write_b128 v53, v[108:111] offset:16
    v_cmp_lt_u32 vcc, 6, v36
    s_nop 0
    s_and_b64 exec, exec, vcc
    s_nop 1
    s_cbranch_execz K2_SCATTERED
    v_add_lshl_u32 v54, v54, v46, 5
    v_add_u32 v54, 103552, v54
    ds_write_b128 v54, v[112:115]
    ds_write_b128 v54, v[116:119] offset:16
    v_cmp_lt_u32 vcc, 7, v36
    s_nop 0
    s_and_b64 exec, exec, vcc
    s_nop 1
    s_cbranch_execz K2_SCATTERED
    v_add_lshl_u32 v55, v55, v47, 5
    v_add_u32 v55, 103552, v55
    ds_write_b128 v55, v[120:123]
    ds_write_b128 v55, v[124:127] offset:16
K2_SCATTERED:
    s_mov_b64 exec, -1
    v_add_u32 v196, 16, v182
    v_lshl_add_u32 v197, v1, 1, 1
    v_cmp_le_u32_e64 s[64:65], v184, v196
    v_cmp_le_u32_e64 s[66:67], v185, v196
    v_cmp_le_u32_e64 s[68:69], v186, v196
    v_cmp_le_u32_e64 s[70:71], v187, v196
    v_cmp_le_u32_e64 s[72:73], v188, v196
    v_cmp_le_u32_e64 s[74:75], v189, v196
    v_cmp_le_u32_e64 s[76:77], v190, v196
    v_addc_co_u32_e64 v197, vcc, 0, v197, s[64:65]
    v_addc_co_u32_e64 v197, vcc, 0, v197, s[66:67]
    v_addc_co_u32_e64 v197, vcc, 0, v197, s[68:69]
    v_addc_co_u32_e64 v197, vcc, 0, v197, s[70:71]
    v_addc_co_u32_e64 v197, vcc, 0, v197, s[72:73]
    v_addc_co_u32_e64 v197, vcc, 0, v197, s[74:75]
    v_addc_co_u32_e64 v197, vcc, 0, v197, s[76:77]
    v_min_u32 v197, s30, v197
    v_add_u32 v198, 16, v183
    v_lshl_add_u32 v199, v1, 1, 2
    v_cmp_le_u32_e64 s[64:65], v185, v198
    v_cmp_le_u32_e64 s[66:67], v186, v198
    v_cmp_le_u32_e64 s[68:69], v187, v198
    v_cmp_le_u32_e64 s[70:71], v188, v198
    v_cmp_le_u32_e64 s[72:73], v189, v198
    v_cmp_le_u32_e64 s[74:75], v190, v198
    v_cmp_le_u32_e64 s[76:77], v191, v198
    v_addc_co_u32_e64 v199, vcc, 0, v199, s[64:65]
    v_addc_co_u32_e64 v199, vcc, 0, v199, s[66:67]
    v_addc_co_u32_e64 v199, vcc, 0, v199, s[68:69]
    v_addc_co_u32_e64 v199, vcc, 0, v199, s[70:71]
    v_addc_co_u32_e64 v199, vcc, 0, v199, s[72:73]
    v_addc_co_u32_e64 v199, vcc, 0, v199, s[74:75]
    v_addc_co_u32_e64 v199, vcc, 0, v199, s[76:77]
    v_min_u32 v199, s30, v199
    v_lshl_or_b32 v16, v199, 8, v197
    s_mov_b32 s51, 0
    s_mov_b32 s36, s3
    s_nop 0
K2_WALK0:
    s_cmp_eq_u32 s36, 0
    s_cbranch_scc1 K2_WALK0_DONE
    s_lshr_b32 s48, s51, 1
    v_readlane_b32 s49, v16, s48
    s_and_b32 s50, s51, 1
    s_lshl_b32 s50, s50, 3
    s_lshr_b32 s49, s49, s50
    s_and_b32 s51, s49, 0xff
    s_sub_u32 s36, s36, 1
    s_branch K2_WALK0
K2_WALK0_DONE:
    s_mov_b32 s42, s51
    s_lshr_b32 s48, s51, 1
    v_readlane_b32 s49, v17, s48
    s_and_b32 s50, s51, 1
    s_lshl_b32 s50, s50, 4
    s_lshr_b32 s49, s49, s50
    s_and_b32 s44, s49, 0xffff
    s_lshr_b32 s48, s51, 1
    v_readlane_b32 s49, v16, s48
    s_and_b32 s50, s51, 1
    s_lshl_b32 s50, s50, 3
    s_lshr_b32 s49, s49, s50
    s_and_b32 s51, s49, 0xff
    s_lshr_b32 s48, s51, 1
    v_readlane_b32 s49, v17, s48
    s_and_b32 s50, s51, 1
    s_lshl_b32 s50, s50, 4
    s_lshr_b32 s49, s49, s50
    s_and_b32 s46, s49, 0xffff
    s_mov_b32 s88, s34
    s_sub_u32 s43, s51, s42
    s_add_u32 s47, s42, s29
    s_lshl_b32 s47, s47, 10
    s_cmp_eq_u32 s88, 0
    s_cselect_b32 s92, s4, s6
    s_cselect_b32 s93, s5, s7
    s_cselect_b32 s89, 1, 0
    s_cmp_ge_u32 s42, s100
    s_cselect_b32 s101, s89, 0
    s_sub_u32 s45, s46, s44
    s_min_u32 s45, s45, 16
    s_lshl_b32 s59, s44, 5
    s_mov_b32 s90, 1
    s_cmp_lg_u32 s3, 7
    s_cbranch_scc1 K2_NOPUB
    v_mov_b32 v176, 103500
    v_mov_b32 v177, s51
    ds_write_b32 v176, v177
    s_waitcnt lgkmcnt(0)
K2_NOPUB:
    s_waitcnt lgkmcnt(0)
    s_barrier
    v_add_u32 v26, s59, v9
    ds_read_b32 v26, v26
    v_cmp_gt_u32_e64 s[60:61], s45, v5
    s_waitcnt lgkmcnt(0)
    v_lshrrev_b32 v26, 2, v26
    v_add_u32 v26, v26, v7
    v_cndmask_b32_e64 v26, v18, v26, s[60:61]
    buffer_load_dwordx4 v[32:35], v26, s[96:99], 0 offen offset:0
    buffer_load_dwordx4 v[36:39], v26, s[96:99], 0 offen offset:64
    buffer_load_dwordx4 v[40:43], v26, s[96:99], 0 offen offset:128
    buffer_load_dwordx4 v[44:47], v26, s[96:99], 0 offen offset:192
    s_mov_b32 s9, 1
K2_LOOP:
    s_mov_b32 s36, s42
    s_mov_b32 s37, s43
    s_mov_b32 s38, s44
    s_mov_b32 s39, s45
    s_mov_b32 s40, s46
    s_mov_b32 s41, s47
    s_mov_b32 s58, s59
    s_mov_b32 s24, s92
    s_mov_b32 s25, s93
    s_cmp_eq_u32 s37, 0
    s_cbranch_scc1 K2_DONE
    v_mov_b32 v194, 103496
    v_add_u32 v192, s58, v11
    v_add_u32 v193, s58, v10
    ds_read_b64 v[200:201], v194
    ds_read_b128 v[176:179], v193 offset:0
    ds_read_b128 v[180:183], v193 offset:32
    ds_read_b128 v[184:187], v193 offset:64
    ds_read_b128 v[188:191], v193 offset:96
    ds_read_b64 v[28:29], v192
    v_cmp_gt_u32_e64 s[60:61], s37, v15
    v_add_u32 v206, 1, v15
    v_add_u32 v207, 0x400, v14
    v_cmp_gt_u32_e64 s[62:63], s37, v206
    v_cndmask_b32_e64 v19, v18, v14, s[60:61]
    v_add_u32 v196, 0, v6
    v_cmp_gt_u32_e64 s[64:65], s39, v196
    v_add_u32 v197, 1, v6
    v_cmp_gt_u32_e64 s[66:67], s39, v197
    v_add_u32 v198, 2, v6
    v_cmp_gt_u32_e64 s[68:69], s39, v198
    v_add_u32 v199, 3, v6
    v_cmp_gt_u32_e64 s[70:71], s39, v199
    v_cndmask_b32_e64 v20, v18, v207, s[62:63]
    s_sub_u32 s48, s36, s100
    s_lshl_b32 s48, s48, 10
    s_add_u32 s48, s48, 116864
    v_add_u32 v195, s48, v14
    s_xor_b32 s0, s90, 1
    s_mov_b32 s90, 0
    s_waitcnt lgkmcnt(5)
    v_readfirstlane_b32 s48, v200
    v_readfirstlane_b32 s87, v201
    s_waitcnt lgkmcnt(4)
    v_add_u32 v22, v176, v8
    v_cndmask_b32_e64 v22, v18, v22, s[64:65]
    v_subrev_u32 v177, s36, v177
    v_cndmask_b32_e64 v177, -2, v177, s[64:65]
    s_waitcnt lgkmcnt(3)
    v_add_u32 v23, v180, v8
    v_cndmask_b32_e64 v23, v18, v23, s[66:67]
    v_subrev_u32 v181, s36, v181
    v_cndmask_b32_e64 v181, -2, v181, s[66:67]
    s_waitcnt lgkmcnt(2)
    v_add_u32 v24, v184, v8
    v_cndmask_b32_e64 v24, v18, v24, s[68:69]
    v_subrev_u32 v185, s36, v185
    v_cndmask_b32_e64 v185, -2, v185, s[68:69]
    s_waitcnt lgkmcnt(1)
    v_add_u32 v25, v188, v8
    v_cndmask_b32_e64 v25, v18, v25, s[70:71]
    v_subrev_u32 v189, s36, v189
    v_cndmask_b32_e64 v189, -2, v189, s[70:71]
    s_waitcnt lgkmcnt(0)
    s_cmp_eq_u32 s48, 4
    s_cselect_b32 s48, s101, 0
    s_cmp_eq_u32 s48, 0
    s_cbranch_scc1 K2_OWN_GLOBAL
    ds_read_b128 v[96:99], v195 offset:0
    ds_read_b128 v[100:103], v195 offset:1024
    ds_read_b128 v[104:107], v195 offset:256
    ds_read_b128 v[108:111], v195 offset:1280
    ds_read_b128 v[112:115], v195 offset:512
    ds_read_b128 v[116:119], v195 offset:1536
    ds_read_b128 v[120:123], v195 offset:768
    ds_read_b128 v[124:127], v195 offset:1792
    s_branch K2_OWN_DONE
K2_OWN_GLOBAL:
    s_cmp_eq_u32 s88, 0
    s_cbranch_scc1 K2_OWN_GO
    s_waitcnt vmcnt(0)
K2_OWN_GO:
    buffer_load_dwordx4 v[96:99], v19, s[24:27], s41 offen offset:0 nt
    buffer_load_dwordx4 v[100:103], v20, s[24:27], s41 offen offset:0 nt
    buffer_load_dwordx4 v[104:107], v19, s[24:27], s41 offen offset:256
    buffer_load_dwordx4 v[108:111], v20, s[24:27], s41 offen offset:256
    buffer_load_dwordx4 v[112:115], v19, s[24:27], s41 offen offset:512
    buffer_load_dwordx4 v[116:119], v20, s[24:27], s41 offen offset:512
    buffer_load_dwordx4 v[120:123], v19, s[24:27], s41 offen offset:768
    buffer_load_dwordx4 v[124:127], v20, s[24:27], s41 offen offset:768
    s_add_u32 s0, s0, 1
K2_OWN_DONE:
    s_cmp_eq_u32 s9, 0
    s_cbranch_scc1 K2_NOB3
    s_waitcnt vmcnt(13)
    s_barrier
    s_mov_b32 s9, 0
    s_cmp_eq_u32 s1, 0
    s_cbranch_scc1 K2_NOSTGA
    s_add_u32 s48, s29, s100
    s_lshl_b32 s48, s48, 10
    s_add_u32 s48, s48, s91
    s_add_u32 m0, s91, 116864
    s_nop 0
    buffer_load_dwordx4 v2, s[12:15], s48 offen lds
    s_add_u32 m0, m0, 0x1000
    s_add_u32 s48, s48, 0x1000
    buffer_load_dwordx4 v2, s[12:15], s48 offen lds
    s_add_u32 m0, m0, 0x1000
    s_add_u32 s48, s48, 0x1000
    buffer_load_dwordx4 v2, s[12:15], s48 offen lds
    s_add_u32 m0, m0, 0x1000
    s_add_u32 s48, s48, 0x1000
    buffer_load_dwordx4 v2, s[12:15], s48 offen lds
    s_add_u32 m0, m0, 0x1000
    s_add_u32 s48, s48, 0x1000
    buffer_load_dwordx4 v2, s[12:15], s48 offen lds
    s_add_u32 m0, m0, 0x1000
    s_add_u32 s48, s48, 0x1000
    buffer_load_dwordx4 v2, s[12:15], s48 offen lds
    s_add_u32 m0, m0, 0x1000
    s_add_u32 s48, s48, 0x1000
    buffer_load_dwordx4 v2, s[12:15], s48 offen lds
    s_add_u32 m0, m0, 0x1000
    s_add_u32 s48, s48, 0x1000
    buffer_load_dwordx4 v2, s[12:15], s48 offen lds
    s_add_u32 m0, m0, 0x1000
    s_add_u32 s48, s48, 0x1000
    buffer_load_dwordx4 v2, s[12:15], s48 offen lds
    s_add_u32 m0, m0, 0x1000
    s_add_u32 s48, s48, 0x1000
    buffer_load_dwordx4 v2, s[12:15], s48 offen lds
    s_add_u32 m0, m0, 0x1000
    s_add_u32 s48, s48, 0x1000
    buffer_load_dwordx4 v2, s[12:15], s48 offen lds
    s_add_u32 m0, m0, 0x1000
    s_add_u32 s48, s48, 0x1000
    s_add_u32 s0, s0, 1
K2_NOSTGA:
K2_NOB3:
    s_cmp_eq_u32 s0, 1
    s_cbranch_scc1 K2_HW1
    s_cmp_eq_u32 s0, 2
    s_cbranch_scc1 K2_HW2
    s_waitcnt vmcnt(0)
K2_HW1:
    s_waitcnt vmcnt(8)
K2_HW2:
    s_waitcnt vmcnt(16) lgkmcnt(0)
    s_cmp_eq_u32 s39, 0
    s_cbranch_scc1 K2_COPY
    s_setprio 2
    ds_read_b128 v[208:211], v3 offset:0
    ds_read_b128 v[212:215], v3 offset:1024
    ds_read_b128 v[216:219], v3 offset:2048
    ds_read_b128 v[220:223], v3 offset:3072
    ds_read_b128 v[224:227], v3 offset:4096
    ds_read_b128 v[228:231], v3 offset:5120
    ds_read_b128 v[232:235], v3 offset:6144
    ds_read_b64 v[236:237], v4 offset:2048
    v_cmp_gt_u32_e64 s[72:73], s39, v5
    v_cmp_eq_u32_e64 s[74:75], v177, v12
    s_and_b64 s[72:73], s[72:73], s[56:57]
    v_cndmask_b32_e64 v28, 0, v28, s[72:73]
    v_cndmask_b32_e64 v29, 0, v29, s[72:73]
    v_cmp_eq_u32_e64 s[76:77], v181, v12
    v_cmp_eq_u32_e64 s[78:79], v185, v12
    v_cmp_eq_u32_e64 s[80:81], v189, v12
    v_cmp_eq_u32_e64 s[82:83], v177, v13
    v_cmp_eq_u32_e64 s[60:61], v181, v13
    v_cmp_eq_u32_e64 s[62:63], v185, v13
    v_cmp_eq_u32_e64 s[64:65], v189, v13
    v_cndmask_b32_e64 v198, 0, -1, s[74:75]
    v_cndmask_b32_e64 v199, 0, -1, s[76:77]
    v_cndmask_b32_e64 v200, 0, -1, s[78:79]
    v_cndmask_b32_e64 v201, 0, -1, s[80:81]
    v_cndmask_b32_e64 v202, 0, -1, s[82:83]
    v_cndmask_b32_e64 v203, 0, -1, s[60:61]
    v_cndmask_b32_e64 v204, 0, -1, s[62:63]
    v_cndmask_b32_e64 v205, 0, -1, s[64:65]
    s_waitcnt lgkmcnt(4)
    v_mfma_f32_16x16x32_bf16 v[240:243], v[32:35], v[208:211], 0
    ds_read_b128 v[208:211], v3 offset:7168
    v_bfi_b32 v144, s52, v198, v199
    v_mfma_f32_16x16x32_bf16 v[240:243], v[36:39], v[212:215], v[240:243]
    ds_read_b128 v[212:215], v3 offset:8192
    v_bfi_b32 v145, s52, v200, v201
    v_mfma_f32_16x16x32_bf16 v[240:243], v[40:43], v[216:219], v[240:243]
    ds_read_b128 v[216:219], v3 offset:9216
    v_bfi_b32 v146, s52, v202, v203
    v_mfma_f32_16x16x32_bf16 v[240:243], v[44:47], v[220:223], v[240:243]
    ds_read_b128 v[220:223], v3 offset:10240
    ds_read_b64 v[238:239], v4 offset:2176
    s_waitcnt lgkmcnt(4)
    v_mfma_f32_16x16x32_bf16 v[244:247], v[32:35], v[224:227], 0
    ds_read_b128 v[224:227], v3 offset:11264
    v_bfi_b32 v147, s52, v204, v205
    v_mfma_f32_16x16x32_bf16 v[244:247], v[36:39], v[228:231], v[244:247]
    ds_read_b128 v[228:231], v3 offset:12288
    v_perm_b32 v148, v182, v178, s54
    v_mfma_f32_16x16x16_bf16 v[248:251], v[28:29], v[236:237], 0
    v_perm_b32 v150, v182, v178, s55
    v_perm_b32 v152, v183, v179, s54
    v_perm_b32 v149, v190, v186, s54
    v_mfma_f32_16x16x32_bf16 v[244:247], v[40:43], v[232:235], v[244:247]
    ds_read_b128 v[232:235], v3 offset:13312
    v_perm_b32 v151, v190, v186, s55
    v_mfma_f32_16x16x32_bf16 v[244:247], v[44:47], v[208:211], v[244:247]
    ds_read_b128 v[208:211], v3 offset:14336
    ds_read_b64 v[236:237], v4 offset:2304
    v_mul_f32 v248, v240, v248
    v_mul_f32 v249, v241, v249
    v_mul_f32 v250, v242, v250
    v_mul_f32 v251, v243, v251
    s_waitcnt lgkmcnt(4)
    v_mfma_f32_16x16x32_bf16 v[240:243], v[32:35], v[212:215], 0
    ds_read_b128 v[212:215], v3 offset:15360
    v_cvt_pk_bf16_f32 v160, v248, v249
    v_mfma_f32_16x16x32_bf16 v[240:243], v[36:39], v[216:219], v[240:243]
    ds_read_b128 v[216:219], v3 offset:16384
    v_cvt_pk_bf16_f32 v161, v250, v251
    v_mfma_f32_16x16x16_bf16 v[252:255], v[28:29], v[238:239], 0
    v_perm_b32 v153, v191, v187, s54
    v_and_b32 v128, s53, v144
    v_and_b32 v129, s53, v145
    v_mfma_f32_16x16x32_bf16 v[240:243], v[40:43], v[220:223], v[240:243]
    ds_read_b128 v[220:223], v3 offset:17408
    v_and_b32 v130, s53, v146
    v_mfma_f32_16x16x32_bf16 v[240:243], v[44:47], v[224:227], v[240:243]
    ds_read_b128 v[224:227], v3 offset:18432
    ds_read_b64 v[238:239], v4 offset:2432
    v_mul_f32 v252, v244, v252
    v_mul_f32 v253, v245, v253
    v_mul_f32 v254, v246, v254
    s_waitcnt lgkmcnt(5)
    v_mfma_f32_16x16x16_bf16 v[248:251], v[28:29], v[236:237], 0
    v_mul_f32 v255, v247, v255
    v_cvt_pk_bf16_f32 v162, v252, v253
    v_cvt_pk_bf16_f32 v163, v254, v255
    v_mfma_f32_16x16x32_bf16 v[244:247], v[32:35], v[228:231], 0
    ds_read_b128 v[228:231], v3 offset:19456
    v_and_b32 v131, s53, v147
    v_mfma_f32_16x16x32_bf16 v[244:247], v[36:39], v[232:235], v[244:247]
    ds_read_b128 v[232:235], v3 offset:20480
    v_mul_f32 v248, v240, v248
    v_mfma_f32_16x16x32_bf16 v[244:247], v[40:43], v[208:211], v[244:247]
    ds_read_b128 v[208:211], v3 offset:21504
    v_mul_f32 v249, v241, v249
    s_waitcnt lgkmcnt(7)
    v_mfma_f32_16x16x32_bf16 v[244:247], v[44:47], v[212:215], v[244:247]
    ds_read_b128 v[212:215], v3 offset:22528
    ds_read_b64 v[236:237], v4 offset:2560
    v_mul_f32 v250, v242, v250
    v_mul_f32 v251, v243, v251
    s_waitcnt lgkmcnt(4)
    v_mfma_f32_16x16x32_bf16 v[240:243], v[32:35], v[216:219], 0
    ds_read_b128 v[216:219], v3 offset:23552
    v_cvt_pk_bf16_f32 v164, v248, v249
    v_mfma_f32_16x16x32_bf16 v[240:243], v[36:39], v[220:223], v[240:243]
    ds_read_b128 v[220:223], v3 offset:24576
    v_cvt_pk_bf16_f32 v165, v250, v251
    v_mfma_f32_16x16x16_bf16 v[252:255], v[28:29], v[238:239], 0
    v_and_b32 v132, v144, v148
    v_and_b32 v133, v145, v149
    v_and_b32 v134, v146, v148
    v_mfma_f32_16x16x32_bf16 v[240:243], v[40:43], v[224:227], v[240:243]
    ds_read_b128 v[224:227], v3 offset:25600
    v_and_b32 v135, v147, v149
    v_mfma_f32_16x16x32_bf16 v[240:243], v[44:47], v[228:231], v[240:243]
    ds_read_b128 v[228:231], v3 offset:26624
    ds_read_b64 v[238:239], v4 offset:2688
    v_mul_f32 v252, v244, v252
    v_mul_f32 v253, v245, v253
    v_mul_f32 v254, v246, v254
    v_mul_f32 v255, v247, v255
    s_waitcnt lgkmcnt(4)
    v_mfma_f32_16x16x32_bf16 v[244:247], v[32:35], v[232:235], 0
    ds_read_b128 v[232:235], v3 offset:27648
    v_cvt_pk_bf16_f32 v166, v252, v253
    v_mfma_f32_16x16x32_bf16 v[244:247], v[36:39], v[208:211], v[244:247]
    ds_read_b128 v[208:211], v3 offset:28672
    v_cvt_pk_bf16_f32 v167, v254, v255
    v_mfma_f32_16x16x16_bf16 v[248:251], v[28:29], v[236:237], 0
    v_and_b32 v136, v144, v150
    v_and_b32 v137, v145, v151
    v_and_b32 v138, v146, v150
    v_mfma_f32_16x16x32_bf16 v[244:247], v[40:43], v[212:215], v[244:247]
    ds_read_b128 v[212:215], v3 offset:29696
    v_and_b32 v139, v147, v151
    v_mfma_f32_16x16x32_bf16 v[244:247], v[44:47], v[216:219], v[244:247]
    ds_read_b128 v[216:219], v3 offset:30720
    ds_read_b64 v[236:237], v4 offset:2816
    v_mul_f32 v248, v240, v248
    v_mul_f32 v249, v241, v249
    v_mul_f32 v250, v242, v250
    s_waitcnt lgkmcnt(5)
    v_mfma_f32_16x16x16_bf16 v[252:255], v[28:29], v[238:239], 0
    v_mul_f32 v251, v243, v251
    v_cvt_pk_bf16_f32 v168, v248, v249
    v_cvt_pk_bf16_f32 v169, v250, v251
    v_mfma_f32_16x16x32_bf16 v[240:243], v[32:35], v[220:223], 0
    ds_read_b128 v[220:223], v3 offset:31744
    v_and_b32 v140, v144, v152
    v_mfma_f32_16x16x32_bf16 v[240:243], v[36:39], v[224:227], v[240:243]
    ds_read_b128 v[224:227], v2 offset:0
    v_mul_f32 v252, v244, v252
    v_mfma_f32_16x16x32_bf16 v[240:243], v[40:43], v[228:231], v[240:243]
    ds_read_b128 v[228:231], v2 offset:1024
    v_mul_f32 v253, v245, v253
    s_waitcnt lgkmcnt(7)
    v_mfma_f32_16x16x32_bf16 v[240:243], v[44:47], v[232:235], v[240:243]
    ds_read_b128 v[232:235], v2 offset:2048
    ds_read_b64 v[238:239], v4 offset:2944
    v_mul_f32 v254, v246, v254
    v_mul_f32 v255, v247, v255
    s_waitcnt lgkmcnt(4)
    v_mfma_f32_16x16x32_bf16 v[244:247], v[32:35], v[208:211], 0
    ds_read_b128 v[208:211], v2 offset:3072
    v_cvt_pk_bf16_f32 v170, v252, v253
    v_mfma_f32_16x16x32_bf16 v[244:247], v[36:39], v[212:215], v[244:247]
    ds_read_b128 v[212:215], v2 offset:4096
    v_cvt_pk_bf16_f32 v171, v254, v255
    v_mfma_f32_16x16x32_bf16 v[244:247], v[40:43], v[216:219], v[244:247]
    ds_read_b128 v[216:219], v2 offset:5120
    v_and_b32 v141, v145, v153
    v_mfma_f32_16x16x16_bf16 v[248:251], v[28:29], v[236:237], 0
    v_and_b32 v142, v146, v152
    v_and_b32 v143, v147, v153
    buffer_load_dwordx4 v[48:51], v22, s[12:15], 0 offen offset:256
    v_mfma_f32_16x16x32_bf16 v[244:247], v[44:47], v[220:223], v[244:247]
    ds_read_b128 v[220:223], v2 offset:6144
    ds_read_b64 v[236:237], v4 offset:0
    buffer_load_dwordx4 v[52:55], v23, s[12:15], 0 offen offset:256
    s_nop 0
    v_mul_f32 v248, v240, v248
    v_mul_f32 v249, v241, v249
    v_mul_f32 v250, v242, v250
    s_waitcnt lgkmcnt(5)
    v_mfma_f32_16x16x16_bf16 v[252:255], v[28:29], v[238:239], 0
    v_mul_f32 v251, v243, v251
    v_cvt_pk_bf16_f32 v172, v248, v249
    v_cvt_pk_bf16_f32 v173, v250, v251
    v_mfma_f32_16x16x32_bf16 v[240:243], v[32:35], v[224:227], 0
    ds_read_b128 v[224:227], v2 offset:7168
    buffer_load_dwordx4 v[56:59], v24, s[12:15], 0 offen offset:256
    v_mfma_f32_16x16x32_bf16 v[240:243], v[36:39], v[228:231], v[240:243]
    ds_read_b128 v[228:231], v2 offset:8192
    v_mul_f32 v252, v244, v252
    v_mfma_f32_16x16x32_bf16 v[240:243], v[40:43], v[232:235], v[240:243]
    ds_read_b128 v[232:235], v2 offset:9216
    v_mul_f32 v253, v245, v253
    s_waitcnt lgkmcnt(7)
    v_mfma_f32_16x16x32_bf16 v[240:243], v[44:47], v[208:211], v[240:243]
    ds_read_b128 v[208:211], v2 offset:10240
    v_mul_f32 v254, v246, v254
    v_mul_f32 v255, v247, v255
    s_waitcnt lgkmcnt(3)
    v_mfma_f32_16x16x32_bf16 v[244:247], v[32:35], v[212:215], 0
    ds_read_b64 v[238:239], v4 offset:128
    ds_read_b128 v[212:215], v2 offset:11264
    v_mfma_f32_16x16x16_bf16 v[248:251], v[28:29], v[236:237], 0
    v_cvt_pk_bf16_f32 v174, v252, v253
    v_cvt_pk_bf16_f32 v175, v254, v255
    buffer_load_dwordx4 v[60:63], v25, s[12:15], 0 offen offset:256
    v_mfma_f32_16x16x32_bf16 v[244:247], v[36:39], v[216:219], v[244:247]
    ds_read_b128 v[216:219], v2 offset:12288
    buffer_load_dwordx4 v[64:67], v22, s[12:15], 0 offen offset:512
    v_mfma_f32_16x16x32_bf16 v[244:247], v[40:43], v[220:223], v[244:247]
    s_nop 0
    v_mul_f32 v248, v240, v248
    v_mul_f32 v249, v241, v249
    v_mfma_f32_16x16x32_bf16 v[244:247], v[44:47], v[224:227], v[244:247]
    v_mul_f32 v250, v242, v250
    v_mul_f32 v251, v243, v251
    s_waitcnt lgkmcnt(1)
    v_mfma_f32_16x16x32_bf16 v[240:243], v[32:35], v[228:231], 0
    ds_read_b128 v[220:223], v2 offset:13312
    ds_read_b128 v[224:227], v2 offset:14336
    v_mfma_f32_16x16x32_bf16 v[240:243], v[36:39], v[232:235], v[240:243]
    ds_read_b64 v[236:237], v4 offset:256
    ds_read_b128 v[228:231], v2 offset:15360
    v_mfma_f32_16x16x32_bf16 v[240:243], v[40:43], v[208:211], v[240:243]
    ds_read_b128 v[232:235], v2 offset:16384
    ds_read_b128 v[208:211], v2 offset:17408
    v_mfma_f32_16x16x32_bf16 v[240:243], v[44:47], v[212:215], v[240:243]
    ds_read_b128 v[212:215], v2 offset:18432
    v_cvt_pk_bf16_f32 v144, v248, v249
    v_mfma_f32_16x16x16_bf16 v[252:255], v[28:29], v[238:239], 0
    v_cvt_pk_bf16_f32 v145, v250, v251
    ds_read_b64 v[238:239], v4 offset:384
    buffer_load_dwordx4 v[68:71], v23, s[12:15], 0 offen offset:512
    buffer_load_dwordx4 v[72:75], v24, s[12:15], 0 offen offset:512
    buffer_load_dwordx4 v[76:79], v25, s[12:15], 0 offen offset:512
    buffer_load_dwordx4 v[80:83], v22, s[12:15], 0 offen offset:768
    buffer_load_dwordx4 v[84:87], v23, s[12:15], 0 offen offset:768
    s_nop 0
    v_mul_f32 v252, v244, v252
    v_mul_f32 v253, v245, v253
    v_mul_f32 v254, v246, v254
    v_mul_f32 v255, v247, v255
    s_waitcnt lgkmcnt(4)
    v_mfma_f32_16x16x32_bf16 v[244:247], v[32:35], v[216:219], 0
    v_cvt_pk_bf16_f32 v146, v252, v253
    v_cvt_pk_bf16_f32 v147, v254, v255
    v_mfma_f32_16x16x32_bf16 v[244:247], v[36:39], v[220:223], v[244:247]
    buffer_load_dwordx4 v[88:91], v24, s[12:15], 0 offen offset:768
    ds_read_b128 v[216:219], v2 offset:19456
    v_mfma_f32_16x16x32_bf16 v[244:247], v[40:43], v[224:227], v[244:247]
    buffer_load_dwordx4 v[92:95], v25, s[12:15], 0 offen offset:768
    ds_read_b128 v[220:223], v2 offset:20480
    v_mfma_f32_16x16x16_bf16 v[248:251], v[28:29], v[236:237], 0
    ds_read_b128 v[224:227], v2 offset:21504
    v_mfma_f32_16x16x32_bf16 v[244:247], v[44:47], v[228:231], v[244:247]
    ds_read_b128 v[228:231], v2 offset:22528
    s_waitcnt lgkmcnt(4)
    v_mfma_f32_16x16x16_bf16 v[252:255], v[28:29], v[238:239], 0
    s_nop 2
    v_mul_f32 v248, v240, v248
    v_mul_f32 v249, v241, v249
    v_mul_f32 v250, v242, v250
    v_mul_f32 v251, v243, v251
    v_cvt_pk_bf16_f32 v148, v248, v249
    v_cvt_pk_bf16_f32 v149, v250, v251
    v_mul_f32 v252, v244, v252
    v_mul_f32 v253, v245, v253
    v_mul_f32 v254, v246, v254
    v_mul_f32 v255, v247, v255
    v_cvt_pk_bf16_f32 v150, v252, v253
    v_cvt_pk_bf16_f32 v151, v254, v255
    v_mov_b32 v176, 103500
    ds_read_b32 v179, v176
    s_add_u32 s44, s38, 16
    s_mov_b32 s88, 1
    s_waitcnt lgkmcnt(0)
    v_readfirstlane_b32 s87, v179
    s_cmp_lt_u32 s44, s40
    s_nop 2
    s_cbranch_scc1 K2_CLAIMED
    s_mov_b32 s88, s34
K2_CLAIM:
    s_mov_b32 s51, s87
    s_mov_b32 s42, s87
    v_mov_b32 v177, s87
    s_lshr_b32 s48, s51, 1
    v_readlane_b32 s49, v16, s48
    s_and_b32 s50, s51, 1
    s_lshl_b32 s50, s50, 3
    s_lshr_b32 s49, s49, s50
    s_and_b32 s51, s49, 0xff
    v_mov_b32 v178, s51
    s_mov_b64 exec, 1
    ds_cmpst_rtn_b32 v179, v176, v177, v178
    s_mov_b64 exec, -1
    s_lshr_b32 s48, s51, 1
    v_readlane_b32 s49, v17, s48
    s_and_b32 s50, s51, 1
    s_lshl_b32 s50, s50, 4
    s_lshr_b32 s49, s49, s50
    s_and_b32 s46, s49, 0xffff
    s_mov_b32 s86, s51
    s_mov_b32 s51, s42
    s_lshr_b32 s48, s51, 1
    v_readlane_b32 s49, v17, s48
    s_and_b32 s50, s51, 1
    s_lshl_b32 s50, s50, 4
    s_lshr_b32 s49, s49, s50
    s_and_b32 s44, s49, 0xffff
    s_mov_b32 s51, s86
    s_waitcnt lgkmcnt(0)
    v_readfirstlane_b32 s87, v179
    s_nop 0
    s_cmp_lg_u32 s87, s42
    s_nop 1
    s_cbranch_scc1 K2_CLAIM
K2_CLAIMED:
    v_mfma_f32_16x16x32_bf16 v[240:243], v[32:35], v[232:235], 0
    ds_read_b64 v[236:237], v4 offset:512
    ds_read_b128 v[232:235], v2 offset:23552
    v_mfma_f32_16x16x32_bf16 v[240:243], v[36:39], v[208:211], v[240:243]
    ds_read_b128 v[208:211], v2 offset:24576
    s_sub_u32 s43, s51, s42
    v_mfma_f32_16x16x32_bf16 v[240:243], v[40:43], v[212:215], v[240:243]
    ds_read_b128 v[212:215], v2 offset:25600
    s_add_u32 s47, s42, s29
    v_mfma_f32_16x16x32_bf16 v[240:243], v[44:47], v[216:219], v[240:243]
    ds_read_b128 v[216:219], v2 offset:26624
    ds_read_b64 v[238:239], v4 offset:640
    v_mfma_f32_16x16x32_bf16 v[244:247], v[32:35], v[220:223], 0
    ds_read_b128 v[220:223], v2 offset:27648
    s_lshl_b32 s47, s47, 10
    v_mfma_f32_16x16x32_bf16 v[244:247], v[36:39], v[224:227], v[244:247]
    ds_read_b128 v[224:227], v2 offset:28672
    s_cmp_eq_u32 s88, 0
    v_mfma_f32_16x16x32_bf16 v[244:247], v[40:43], v[228:231], v[244:247]
    ds_read_b128 v[228:231], v2 offset:29696
    s_cselect_b32 s92, s4, s6
    s_cselect_b32 s93, s5, s7
    s_cselect_b32 s89, 1, 0
    s_waitcnt lgkmcnt(8)
    v_mfma_f32_16x16x16_bf16 v[248:251], v[28:29], v[236:237], 0
    s_cmp_ge_u32 s42, s100
    s_cselect_b32 s101, s89, 0
    s_sub_u32 s45, s46, s44
    s_waitcnt lgkmcnt(7)
    v_mfma_f32_16x16x32_bf16 v[244:247], v[44:47], v[232:235], v[244:247]
    ds_read_b128 v[232:235], v2 offset:30720
    ds_read_b64 v[236:237], v4 offset:768
    s_min_u32 s45, s45, 16
    s_lshl_b32 s59, s44, 5
    v_mul_f32 v248, v240, v248
    v_mul_f32 v249, v241, v249
    v_mul_f32 v250, v242, v250
    s_waitcnt lgkmcnt(5)
    v_mfma_f32_16x16x16_bf16 v[252:255], v[28:29], v[238:239], 0
    v_mul_f32 v251, v243, v251
    v_cvt_pk_bf16_f32 v152, v248, v249
    v_cvt_pk_bf16_f32 v153, v250, v251
    v_mfma_f32_16x16x32_bf16 v[240:243], v[32:35], v[208:211], 0
    ds_read_b128 v[208:211], v2 offset:31744
    v_add_u32 v26, s59, v9
    v_mfma_f32_16x16x32_bf16 v[240:243], v[36:39], v[212:215], v[240:243]
    ds_read_b128 v[212:215], v2 offset:32768
    v_mul_f32 v252, v244, v252
    v_mfma_f32_16x16x32_bf16 v[240:243], v[40:43], v[216:219], v[240:243]
    ds_read_b128 v[216:219], v2 offset:33792
    v_mul_f32 v253, v245, v253
    s_waitcnt lgkmcnt(7)
    v_mfma_f32_16x16x32_bf16 v[240:243], v[44:47], v[220:223], v[240:243]
    ds_read_b128 v[220:223], v2 offset:34816
    ds_read_b64 v[238:239], v4 offset:896
    v_mul_f32 v254, v246, v254
    v_mul_f32 v255, v247, v255
    s_waitcnt lgkmcnt(4)
    v_mfma_f32_16x16x32_bf16 v[244:247], v[32:35], v[224:227], 0
    ds_read_b128 v[224:227], v2 offset:35840
    v_cvt_pk_bf16_f32 v154, v252, v253
    v_mfma_f32_16x16x32_bf16 v[244:247], v[36:39], v[228:231], v[244:247]
    ds_read_b128 v[228:231], v2 offset:36864
    v_cvt_pk_bf16_f32 v155, v254, v255
    v_mfma_f32_16x16x16_bf16 v[248:251], v[28:29], v[236:237], 0
    v_cmp_gt_u32_e64 s[66:67], s45, v5
    v_mfma_f32_16x16x32_bf16 v[244:247], v[40:43], v[232:235], v[244:247]
    ds_read_b128 v[232:235], v2 offset:37888
    v_mfma_f32_16x16x32_bf16 v[244:247], v[44:47], v[208:211], v[244:247]
    ds_read_b128 v[208:211], v2 offset:38912
    ds_read_b64 v[236:237], v4 offset:1024
    s_nop 1
    v_mul_f32 v248, v240, v248
    v_mul_f32 v249, v241, v249
    v_mul_f32 v250, v242, v250
    v_mul_f32 v251, v243, v251
    s_waitcnt lgkmcnt(4)
    v_mfma_f32_16x16x32_bf16 v[240:243], v[32:35], v[212:215], 0
    ds_read_b32 v26, v26
    ds_read_b128 v[212:215], v2 offset:39936
    v_mfma_f32_16x16x32_bf16 v[240:243], v[36:39], v[216:219], v[240:243]
    ds_read_b128 v[216:219], v2 offset:40960
    v_cvt_pk_bf16_f32 v156, v248, v249
    v_mfma_f32_16x16x16_bf16 v[252:255], v[28:29], v[238:239], 0
    v_cvt_pk_bf16_f32 v157, v250, v251
    v_mfma_f32_16x16x32_bf16 v[240:243], v[40:43], v[220:223], v[240:243]
    ds_read_b128 v[220:223], v2 offset:41984
    v_mfma_f32_16x16x32_bf16 v[240:243], v[44:47], v[224:227], v[240:243]
    ds_read_b128 v[224:227], v2 offset:43008
    ds_read_b64 v[238:239], v4 offset:1152
    s_nop 1
    v_mul_f32 v252, v244, v252
    v_mul_f32 v253, v245, v253
    v_mul_f32 v254, v246, v254
    s_waitcnt lgkmcnt(6)
    v_mfma_f32_16x16x16_bf16 v[248:251], v[28:29], v[236:237], 0
    v_mul_f32 v255, v247, v255
    v_cvt_pk_bf16_f32 v158, v252, v253
    v_cvt_pk_bf16_f32 v159, v254, v255
    v_mfma_f32_16x16x32_bf16 v[244:247], v[32:35], v[228:231], 0
    ds_read_b128 v[228:231], v2 offset:44032
    s_waitcnt lgkmcnt(6)
    v_lshrrev_b32 v26, 2, v26
    v_mfma_f32_16x16x32_bf16 v[244:247], v[36:39], v[232:235], v[244:247]
    ds_read_b128 v[232:235], v2 offset:45056
    v_mul_f32 v176, v240, v248
    v_mfma_f32_16x16x32_bf16 v[244:247], v[40:43], v[208:211], v[244:247]
    ds_read_b128 v[208:211], v2 offset:46080
    v_mul_f32 v177, v241, v249
    s_waitcnt lgkmcnt(7)
    v_mfma_f32_16x16x32_bf16 v[244:247], v[44:47], v[212:215], v[244:247]
    ds_read_b128 v[212:215], v2 offset:47104
    ds_read_b64 v[236:237], v4 offset:1280
    v_mul_f32 v178, v242, v250
    v_mul_f32 v179, v243, v251
    s_waitcnt lgkmcnt(4)
    v_mfma_f32_16x16x32_bf16 v[240:243], v[32:35], v[216:219], 0
    ds_read_b128 v[216:219], v2 offset:48128
    v_add_u32 v26, v26, v7
    v_mfma_f32_16x16x32_bf16 v[240:243], v[36:39], v[220:223], v[240:243]
    ds_read_b128 v[220:223], v2 offset:49152
    v_cndmask_b32_e64 v26, v18, v26, s[66:67]
    v_mfma_f32_16x16x16_bf16 v[252:255], v[28:29], v[238:239], 0
    v_mfma_f32_16x16x32_bf16 v[240:243], v[40:43], v[224:227], v[240:243]
    ds_read_b128 v[224:227], v2 offset:50176
    v_mfma_f32_16x16x32_bf16 v[240:243], v[44:47], v[228:231], v[240:243]
    ds_read_b128 v[228:231], v2 offset:51200
    ds_read_b64 v[238:239], v4 offset:1408
    s_nop 2
    v_mul_f32 v180, v244, v252
    v_mul_f32 v181, v245, v253
    v_mul_f32 v182, v246, v254
    v_mul_f32 v183, v247, v255
    s_waitcnt lgkmcnt(4)
    v_mfma_f32_16x16x32_bf16 v[244:247], v[32:35], v[232:235], 0
    ds_read_b128 v[232:235], v2 offset:52224
    v_mfma_f32_16x16x32_bf16 v[244:247], v[36:39], v[208:211], v[244:247]
    ds_read_b128 v[208:211], v2 offset:53248
    v_mfma_f32_16x16x16_bf16 v[248:251], v[28:29], v[236:237], 0
    v_mfma_f32_16x16x32_bf16 v[244:247], v[40:43], v[212:215], v[244:247]
    ds_read_b128 v[212:215], v2 offset:54272
    v_mfma_f32_16x16x32_bf16 v[244:247], v[44:47], v[216:219], v[244:247]
    ds_read_b128 v[216:219], v2 offset:55296
    ds_read_b64 v[236:237], v4 offset:1536
    s_nop 2
    v_mul_f32 v184, v240, v248
    v_mul_f32 v185, v241, v249
    v_mul_f32 v186, v242, v250
    s_waitcnt lgkmcnt(5)
    v_mfma_f32_16x16x16_bf16 v[252:255], v[28:29], v[238:239], 0
    v_mul_f32 v187, v243, v251
    v_mfma_f32_16x16x32_bf16 v[240:243], v[32:35], v[220:223], 0
    ds_read_b128 v[220:223], v2 offset:56320
    v_mfma_f32_16x16x32_bf16 v[240:243], v[36:39], v[224:227], v[240:243]
    ds_read_b128 v[224:227], v2 offset:57344
    s_nop 2
    v_mul_f32 v188, v244, v252
    v_mfma_f32_16x16x32_bf16 v[240:243], v[40:43], v[228:231], v[240:243]
    ds_read_b128 v[228:231], v2 offset:58368
    v_mul_f32 v189, v245, v253
    s_waitcnt lgkmcnt(7)
    v_mfma_f32_16x16x32_bf16 v[240:243], v[44:47], v[232:235], v[240:243]
    ds_read_b128 v[232:235], v2 offset:59392
    ds_read_b64 v[238:239], v4 offset:1664
    v_mul_f32 v190, v246, v254
    v_mul_f32 v191, v247, v255
    s_waitcnt lgkmcnt(4)
    v_mfma_f32_16x16x32_bf16 v[244:247], v[32:35], v[208:211], 0
    ds_read_b128 v[208:211], v2 offset:60416
    v_mfma_f32_16x16x32_bf16 v[244:247], v[36:39], v[212:215], v[244:247]
    ds_read_b128 v[212:215], v2 offset:61440
    v_mfma_f32_16x16x16_bf16 v[248:251], v[28:29], v[236:237], 0
    v_mfma_f32_16x16x32_bf16 v[244:247], v[40:43], v[216:219], v[244:247]
    ds_read_b128 v[216:219], v2 offset:62464
    v_mfma_f32_16x16x32_bf16 v[244:247], v[44:47], v[220:223], v[244:247]
    ds_read_b128 v[220:223], v2 offset:63488
    s_nop 3
    v_mul_f32 v192, v240, v248
    v_mul_f32 v193, v241, v249
    v_mul_f32 v194, v242, v250
    v_mul_f32 v195, v243, v251
    s_waitcnt lgkmcnt(3)
    v_mfma_f32_16x16x32_bf16 v[240:243], v[32:35], v[224:227], 0
    ds_read_b64 v[236:237], v4 offset:1792
    ds_read_b128 v[224:227], v2 offset:64512
    v_mfma_f32_16x16x16_bf16 v[252:255], v[28:29], v[238:239], 0
    ds_read_b64 v[238:239], v4 offset:1920
    v_mfma_f32_16x16x32_bf16 v[240:243], v[36:39], v[228:231], v[240:243]
    v_mfma_f32_16x16x32_bf16 v[240:243], v[40:43], v[232:235], v[240:243]
    s_nop 4
    v_mul_f32 v196, v244, v252
    v_mul_f32 v197, v245, v253
    v_mfma_f32_16x16x32_bf16 v[240:243], v[44:47], v[208:211], v[240:243]
    v_mul_f32 v198, v246, v254
    v_mul_f32 v199, v247, v255
    s_waitcnt lgkmcnt(1)
    v_mfma_f32_16x16x32_bf16 v[244:247], v[32:35], v[212:215], 0
    buffer_load_dwordx4 v[32:35], v26, s[96:99], 0 offen offset:0
    v_mfma_f32_16x16x32_bf16 v[244:247], v[36:39], v[216:219], v[244:247]
    buffer_load_dwordx4 v[36:39], v26, s[96:99], 0 offen offset:64
    v_mfma_f32_16x16x32_bf16 v[244:247], v[40:43], v[220:223], v[244:247]
    buffer_load_dwordx4 v[40:43], v26, s[96:99], 0 offen offset:128
    v_mfma_f32_16x16x32_bf16 v[244:247], v[44:47], v[224:227], v[244:247]
    buffer_load_dwordx4 v[44:47], v26, s[96:99], 0 offen offset:192
    v_mfma_f32_16x16x16_bf16 v[248:251], v[28:29], v[236:237], 0
    s_waitcnt lgkmcnt(0)
    v_mfma_f32_16x16x16_bf16 v[252:255], v[28:29], v[238:239], 0
    s_nop 5
    v_mul_f32 v200, v240, v248
    v_mul_f32 v201, v241, v249
    v_mul_f32 v202, v242, v250
    v_mul_f32 v203, v243, v251
    v_mul_f32 v204, v244, v252
    v_mul_f32 v205, v245, v253
    v_mul_f32 v206, v246, v254
    v_mul_f32 v207, v247, v255
    s_setprio 0
    s_waitcnt vmcnt(16)
    s_cmp_eq_u32 s1, 0
    s_cbranch_scc1 K2_NOSIG
    v_mov_b32 v240, 103496
    v_mov_b32 v241, 1
    s_mov_b64 exec, 1
    ds_add_u32 v240, v241
    s_mov_b64 exec, -1
    s_mov_b32 s1, 0
    s_waitcnt lgkmcnt(0)
K2_NOSIG:
    v_lshlrev_b32 v208, v27, v96
    v_lshlrev_b32 v209, v27, v100
    v_and_b32 v210, v21, v96
    v_and_b32 v211, v21, v100
    v_lshlrev_b32 v212, v27, v97
    v_lshlrev_b32 v213, v27, v101
    v_mfma_f32_16x16x32_bf16 v[208:211], v[128:131], v[144:147], v[208:211]
    v_and_b32 v214, v21, v97
    v_and_b32 v215, v21, v101
    v_lshlrev_b32 v216, v27, v98
    v_lshlrev_b32 v217, v27, v102
    v_mfma_f32_16x16x32_bf16 v[212:215], v[128:131], v[148:151], v[212:215]
    v_and_b32 v218, v21, v98
    v_and_b32 v219, v21, v102
    v_lshlrev_b32 v220, v27, v99
    v_lshlrev_b32 v221, v27, v103
    v_mfma_f32_16x16x32_bf16 v[216:219], v[128:131], v[152:155], v[216:219]
    v_and_b32 v222, v21, v99
    v_and_b32 v223, v21, v103
    v_cvt_pk_bf16_f32 v96, v208, v210
    v_cvt_pk_bf16_f32 v97, v212, v214
    v_mfma_f32_16x16x32_bf16 v[220:223], v[128:131], v[156:159], v[220:223]
    v_cvt_pk_bf16_f32 v100, v209, v211
    v_cvt_pk_bf16_f32 v101, v213, v215
    s_nop 0
    v_cvt_pk_bf16_f32 v98, v216, v218
    v_cvt_pk_bf16_f32 v102, v217, v219
    s_nop 2
    v_cvt_pk_bf16_f32 v99, v220, v222
    v_cvt_pk_bf16_f32 v103, v221, v223
    buffer_store_dwordx4 v[96:99], v19, s[16:19], s41 offen offset:0 sc1
    buffer_store_dwordx4 v[100:103], v20, s[16:19], s41 offen offset:0 sc1
    s_waitcnt vmcnt(14)
    v_mfma_f32_4x4x4_16b_bf16 v[208:211], v[30:31], v[48:49], 0
    v_lshlrev_b32 v248, v27, v104
    v_mfma_f32_4x4x4_16b_bf16 v[212:215], v[30:31], v[52:53], 0
    v_lshlrev_b32 v249, v27, v108
    v_mfma_f32_4x4x4_16b_bf16 v[216:219], v[30:31], v[56:57], 0
    v_and_b32 v250, v21, v104
    v_mfma_f32_4x4x4_16b_bf16 v[220:223], v[30:31], v[60:61], 0
    v_and_b32 v251, v21, v108
    v_mfma_f32_4x4x4_16b_bf16 v[224:227], v[30:31], v[50:51], 0
    v_lshlrev_b32 v252, v27, v105
    v_mfma_f32_16x16x32_bf16 v[248:251], v[132:135], v[160:163], v[248:251]
    v_lshlrev_b32 v253, v27, v109
    v_and_b32 v254, v21, v105
    v_mfma_f32_4x4x4_16b_bf16 v[228:231], v[30:31], v[54:55], 0
    v_and_b32 v255, v21, v109
    v_mfma_f32_4x4x4_16b_bf16 v[232:235], v[30:31], v[58:59], 0
    v_mul_f32 v208, v208, v176
    v_mfma_f32_16x16x32_bf16 v[252:255], v[132:135], v[164:167], v[252:255]
    v_mul_f32 v209, v209, v180
    v_mul_f32 v210, v210, v184
    v_mfma_f32_4x4x4_16b_bf16 v[236:239], v[30:31], v[62:63], 0
    v_mul_f32 v211, v211, v188
    v_mul_f32 v212, v212, v177
    v_mul_f32 v213, v213, v181
    v_mul_f32 v214, v214, v185
    v_mul_f32 v215, v215, v189
    v_mul_f32 v216, v216, v178
    v_mul_f32 v217, v217, v182
    v_mul_f32 v218, v218, v186
    v_mul_f32 v219, v219, v190
    v_mul_f32 v220, v220, v179
    v_mul_f32 v221, v221, v183
    v_mul_f32 v222, v222, v187
    v_mul_f32 v223, v223, v191
    v_cvt_pk_bf16_f32 v240, v208, v212
    v_cvt_pk_bf16_f32 v241, v216, v220
    v_cvt_pk_bf16_f32 v242, v209, v213
    v_cvt_pk_bf16_f32 v243, v217, v221
    v_cvt_pk_bf16_f32 v244, v210, v214
    v_cvt_pk_bf16_f32 v245, v218, v222
    v_mfma_f32_16x16x32_bf16 v[248:251], v[128:131], v[240:243], v[248:251]
    v_cvt_pk_bf16_f32 v246, v211, v215
    v_cvt_pk_bf16_f32 v247, v219, v223
    v_mul_f32 v224, v224, v192
    v_mul_f32 v225, v225, v196
    v_mfma_f32_16x16x32_bf16 v[252:255], v[128:131], v[244:247], v[252:255]
    v_mul_f32 v226, v226, v200
    v_mul_f32 v227, v227, v204
    s_nop 0
    v_cvt_pk_bf16_f32 v104, v248, v250
    v_cvt_pk_bf16_f32 v108, v249, v251
    v_lshlrev_b32 v248, v27, v106
    v_lshlrev_b32 v249, v27, v110
    v_and_b32 v250, v21, v106
    v_and_b32 v251, v21, v110
    v_cvt_pk_bf16_f32 v105, v252, v254
    v_cvt_pk_bf16_f32 v109, v253, v255
    v_mfma_f32_16x16x32_bf16 v[248:251], v[132:135], v[168:171], v[248:251]
    v_lshlrev_b32 v252, v27, v107
    v_lshlrev_b32 v253, v27, v111
    v_and_b32 v254, v21, v107
    v_and_b32 v255, v21, v111
    v_mul_f32 v228, v228, v193
    v_mul_f32 v229, v229, v197
    v_mfma_f32_16x16x32_bf16 v[252:255], v[132:135], v[172:175], v[252:255]
    v_mul_f32 v230, v230, v201
    v_mul_f32 v231, v231, v205
    v_mul_f32 v232, v232, v194
    v_mul_f32 v233, v233, v198
    v_mul_f32 v234, v234, v202
    v_mul_f32 v235, v235, v206
    v_mul_f32 v236, v236, v195
    v_mul_f32 v237, v237, v199
    v_mul_f32 v238, v238, v203
    v_mul_f32 v239, v239, v207
    v_cvt_pk_bf16_f32 v240, v224, v228
    v_cvt_pk_bf16_f32 v241, v232, v236
    v_cvt_pk_bf16_f32 v242, v225, v229
    v_cvt_pk_bf16_f32 v243, v233, v237
    v_cvt_pk_bf16_f32 v244, v226, v230
    v_cvt_pk_bf16_f32 v245, v234, v238
    v_mfma_f32_16x16x32_bf16 v[248:251], v[128:131], v[240:243], v[248:251]
    v_cvt_pk_bf16_f32 v246, v227, v231
    v_cvt_pk_bf16_f32 v247, v235, v239
    s_nop 1
    v_mfma_f32_16x16x32_bf16 v[252:255], v[128:131], v[244:247], v[252:255]
    s_nop 2
    v_cvt_pk_bf16_f32 v106, v248, v250
    v_cvt_pk_bf16_f32 v110, v249, v251
    s_nop 2
    v_cvt_pk_bf16_f32 v107, v252, v254
    v_cvt_pk_bf16_f32 v111, v253, v255
    buffer_store_dwordx4 v[104:107], v19, s[16:19], s41 offen offset:256 sc1
    buffer_store_dwordx4 v[108:111], v20, s[16:19], s41 offen offset:256 sc1
    s_waitcnt vmcnt(12)
    v_mfma_f32_4x4x4_16b_bf16 v[208:211], v[30:31], v[64:65], 0
    v_lshlrev_b32 v248, v27, v112
    v_mfma_f32_4x4x4_16b_bf16 v[212:215], v[30:31], v[68:69], 0
    v_lshlrev_b32 v249, v27, v116
    v_mfma_f32_4x4x4_16b_bf16 v[216:219], v[30:31], v[72:73], 0
    v_and_b32 v250, v21, v112
    v_mfma_f32_4x4x4_16b_bf16 v[220:223], v[30:31], v[76:77], 0
    v_and_b32 v251, v21, v116
    v_mfma_f32_4x4x4_16b_bf16 v[224:227], v[30:31], v[66:67], 0
    v_lshlrev_b32 v252, v27, v113
    v_mfma_f32_16x16x32_bf16 v[248:251], v[136:139], v[160:163], v[248:251]
    v_lshlrev_b32 v253, v27, v117
    v_and_b32 v254, v21, v113
    v_mfma_f32_4x4x4_16b_bf16 v[228:231], v[30:31], v[70:71], 0
    v_and_b32 v255, v21, v117
    v_mfma_f32_4x4x4_16b_bf16 v[232:235], v[30:31], v[74:75], 0
    v_mul_f32 v208, v208, v176
    v_mfma_f32_16x16x32_bf16 v[252:255], v[136:139], v[164:167], v[252:255]
    v_mul_f32 v209, v209, v180
    v_mul_f32 v210, v210, v184
    v_mfma_f32_4x4x4_16b_bf16 v[236:239], v[30:31], v[78:79], 0
    v_mul_f32 v211, v211, v188
    v_mul_f32 v212, v212, v177
    v_mul_f32 v213, v213, v181
    v_mul_f32 v214, v214, v185
    v_mul_f32 v215, v215, v189
    v_mul_f32 v216, v216, v178
    v_mul_f32 v217, v217, v182
    v_mul_f32 v218, v218, v186
    v_mul_f32 v219, v219, v190
    v_mul_f32 v220, v220, v179
    v_mul_f32 v221, v221, v183
    v_mul_f32 v222, v222, v187
    v_mul_f32 v223, v223, v191
    v_cvt_pk_bf16_f32 v240, v208, v212
    v_cvt_pk_bf16_f32 v241, v216, v220
    v_cvt_pk_bf16_f32 v242, v209, v213
    v_cvt_pk_bf16_f32 v243, v217, v221
    v_cvt_pk_bf16_f32 v244, v210, v214
    v_cvt_pk_bf16_f32 v245, v218, v222
    v_mfma_f32_16x16x32_bf16 v[248:251], v[128:131], v[240:243], v[248:251]
    v_cvt_pk_bf16_f32 v246, v211, v215
    v_cvt_pk_bf16_f32 v247, v219, v223
    v_mul_f32 v224, v224, v192
    v_mul_f32 v225, v225, v196
    v_mfma_f32_16x16x32_bf16 v[252:255], v[128:131], v[244:247], v[252:255]
    v_mul_f32 v226, v226, v200
    v_mul_f32 v227, v227, v204
    s_nop 0
    v_cvt_pk_bf16_f32 v112, v248, v250
    v_cvt_pk_bf16_f32 v116, v249, v251
    v_lshlrev_b32 v248, v27, v114
    v_lshlrev_b32 v249, v27, v118
    v_and_b32 v250, v21, v114
    v_and_b32 v251, v21, v118
    v_cvt_pk_bf16_f32 v113, v252, v254
    v_cvt_pk_bf16_f32 v117, v253, v255
    v_mfma_f32_16x16x32_bf16 v[248:251], v[136:139], v[168:171], v[248:251]
    v_lshlrev_b32 v252, v27, v115
    v_lshlrev_b32 v253, v27, v119
    v_and_b32 v254, v21, v115
    v_and_b32 v255, v21, v119
    v_mul_f32 v228, v228, v193
    v_mul_f32 v229, v229, v197
    v_mfma_f32_16x16x32_bf16 v[252:255], v[136:139], v[172:175], v[252:255]
    v_mul_f32 v230, v230, v201
    v_mul_f32 v231, v231, v205
    v_mul_f32 v232, v232, v194
    v_mul_f32 v233, v233, v198
    v_mul_f32 v234, v234, v202
    v_mul_f32 v235, v235, v206
    v_mul_f32 v236, v236, v195
    v_mul_f32 v237, v237, v199
    v_mul_f32 v238, v238, v203
    v_mul_f32 v239, v239, v207
    v_cvt_pk_bf16_f32 v240, v224, v228
    v_cvt_pk_bf16_f32 v241, v232, v236
    v_cvt_pk_bf16_f32 v242, v225, v229
    v_cvt_pk_bf16_f32 v243, v233, v237
    v_cvt_pk_bf16_f32 v244, v226, v230
    v_cvt_pk_bf16_f32 v245, v234, v238
    v_mfma_f32_16x16x32_bf16 v[248:251], v[128:131], v[240:243], v[248:251]
    v_cvt_pk_bf16_f32 v246, v227, v231
    v_cvt_pk_bf16_f32 v247, v235, v239
    s_nop 1
    v_mfma_f32_16x16x32_bf16 v[252:255], v[128:131], v[244:247], v[252:255]
    s_nop 2
    v_cvt_pk_bf16_f32 v114, v248, v250
    v_cvt_pk_bf16_f32 v118, v249, v251
    s_nop 2
    v_cvt_pk_bf16_f32 v115, v252, v254
    v_cvt_pk_bf16_f32 v119, v253, v255
    buffer_store_dwordx4 v[112:115], v19, s[16:19], s41 offen offset:512 sc1
    buffer_store_dwordx4 v[116:119], v20, s[16:19], s41 offen offset:512 sc1
    s_waitcnt vmcnt(10)
    v_mfma_f32_4x4x4_16b_bf16 v[208:211], v[30:31], v[80:81], 0
    v_lshlrev_b32 v248, v27, v120
    v_mfma_f32_4x4x4_16b_bf16 v[212:215], v[30:31], v[84:85], 0
    v_lshlrev_b32 v249, v27, v124
    v_mfma_f32_4x4x4_16b_bf16 v[216:219], v[30:31], v[88:89], 0
    v_and_b32 v250, v21, v120
    v_mfma_f32_4x4x4_16b_bf16 v[220:223], v[30:31], v[92:93], 0
    v_and_b32 v251, v21, v124
    v_mfma_f32_4x4x4_16b_bf16 v[224:227], v[30:31], v[82:83], 0
    v_lshlrev_b32 v252, v27, v121
    v_mfma_f32_16x16x32_bf16 v[248:251], v[140:143], v[160:163], v[248:251]
    v_lshlrev_b32 v253, v27, v125
    v_and_b32 v254, v21, v121
    v_mfma_f32_4x4x4_16b_bf16 v[228:231], v[30:31], v[86:87], 0
    v_and_b32 v255, v21, v125
    v_mfma_f32_4x4x4_16b_bf16 v[232:235], v[30:31], v[90:91], 0
    v_mul_f32 v208, v208, v176
    v_mfma_f32_16x16x32_bf16 v[252:255], v[140:143], v[164:167], v[252:255]
    v_mul_f32 v209, v209, v180
    v_mul_f32 v210, v210, v184
    v_mfma_f32_4x4x4_16b_bf16 v[236:239], v[30:31], v[94:95], 0
    v_mul_f32 v211, v211, v188
    v_mul_f32 v212, v212, v177
    v_mul_f32 v213, v213, v181
    v_mul_f32 v214, v214, v185
    v_mul_f32 v215, v215, v189
    v_mul_f32 v216, v216, v178
    v_mul_f32 v217, v217, v182
    v_mul_f32 v218, v218, v186
    v_mul_f32 v219, v219, v190
    v_mul_f32 v220, v220, v179
    v_mul_f32 v221, v221, v183
    v_mul_f32 v222, v222, v187
    v_mul_f32 v223, v223, v191
    v_cvt_pk_bf16_f32 v240, v208, v212
    v_cvt_pk_bf16_f32 v241, v216, v220
    v_cvt_pk_bf16_f32 v242, v209, v213
    v_cvt_pk_bf16_f32 v243, v217, v221
    v_cvt_pk_bf16_f32 v244, v210, v214
    v_cvt_pk_bf16_f32 v245, v218, v222
    v_mfma_f32_16x16x32_bf16 v[248:251], v[128:131], v[240:243], v[248:251]
    v_cvt_pk_bf16_f32 v246, v211, v215
    v_cvt_pk_bf16_f32 v247, v219, v223
    v_mul_f32 v224, v224, v192
    v_mul_f32 v225, v225, v196
    v_mfma_f32_16x16x32_bf16 v[252:255], v[128:131], v[244:247], v[252:255]
    v_mul_f32 v226, v226, v200
    v_mul_f32 v227, v227, v204
    s_nop 0
    v_cvt_pk_bf16_f32 v120, v248, v250
    v_cvt_pk_bf16_f32 v124, v249, v251
    v_lshlrev_b32 v248, v27, v122
    v_lshlrev_b32 v249, v27, v126
    v_and_b32 v250, v21, v122
    v_and_b32 v251, v21, v126
    v_cvt_pk_bf16_f32 v121, v252, v254
    v_cvt_pk_bf16_f32 v125, v253, v255
    v_mfma_f32_16x16x32_bf16 v[248:251], v[140:143], v[168:171], v[248:251]
    v_lshlrev_b32 v252, v27, v123
    v_lshlrev_b32 v253, v27, v127
    v_and_b32 v254, v21, v123
    v_and_b32 v255, v21, v127
    v_mul_f32 v228, v228, v193
    v_mul_f32 v229, v229, v197
    v_mfma_f32_16x16x32_bf16 v[252:255], v[140:143], v[172:175], v[252:255]
    v_mul_f32 v230, v230, v201
    v_mul_f32 v231, v231, v205
    v_mul_f32 v232, v232, v194
    v_mul_f32 v233, v233, v198
    v_mul_f32 v234, v234, v202
    v_mul_f32 v235, v235, v206
    v_mul_f32 v236, v236, v195
    v_mul_f32 v237, v237, v199
    v_mul_f32 v238, v238, v203
    v_mul_f32 v239, v239, v207
    v_cvt_pk_bf16_f32 v240, v224, v228
    v_cvt_pk_bf16_f32 v241, v232, v236
    v_cvt_pk_bf16_f32 v242, v225, v229
    v_cvt_pk_bf16_f32 v243, v233, v237
    v_cvt_pk_bf16_f32 v244, v226, v230
    v_cvt_pk_bf16_f32 v245, v234, v238
    v_mfma_f32_16x16x32_bf16 v[248:251], v[128:131], v[240:243], v[248:251]
    v_cvt_pk_bf16_f32 v246, v227, v231
    v_cvt_pk_bf16_f32 v247, v235, v239
    s_nop 1
    v_mfma_f32_16x16x32_bf16 v[252:255], v[128:131], v[244:247], v[252:255]
    s_nop 2
    v_cvt_pk_bf16_f32 v122, v248, v250
    v_cvt_pk_bf16_f32 v126, v249, v251
    s_nop 2
    v_cvt_pk_bf16_f32 v123, v252, v254
    v_cvt_pk_bf16_f32 v127, v253, v255
    buffer_store_dwordx4 v[120:123], v19, s[16:19], s41 offen offset:768 sc1
    buffer_store_dwordx4 v[124:127], v20, s[16:19], s41 offen offset:768 sc1
    s_nop 0
    s_branch K2_LOOP
K2_COPY:
    buffer_load_dwordx4 v[48:51], v22, s[12:15], 0 offen offset:256
    buffer_load_dwordx4 v[52:55], v23, s[12:15], 0 offen offset:256
    buffer_load_dwordx4 v[56:59], v24, s[12:15], 0 offen offset:256
    buffer_load_dwordx4 v[60:63], v25, s[12:15], 0 offen offset:256
    buffer_load_dwordx4 v[64:67], v22, s[12:15], 0 offen offset:512
    buffer_load_dwordx4 v[68:71], v23, s[12:15], 0 offen offset:512
    buffer_load_dwordx4 v[72:75], v24, s[12:15], 0 offen offset:512
    buffer_load_dwordx4 v[76:79], v25, s[12:15], 0 offen offset:512
    buffer_load_dwordx4 v[80:83], v22, s[12:15], 0 offen offset:768
    buffer_load_dwordx4 v[84:87], v23, s[12:15], 0 offen offset:768
    buffer_load_dwordx4 v[88:91], v24, s[12:15], 0 offen offset:768
    buffer_load_dwordx4 v[92:95], v25, s[12:15], 0 offen offset:768
    v_mov_b32 v240, 103500
    ds_read_b32 v243, v240
    s_add_u32 s44, s38, 16
    s_mov_b32 s88, 1
    s_waitcnt lgkmcnt(0)
    v_readfirstlane_b32 s87, v243
    s_cmp_lt_u32 s44, s40
    s_nop 2
    s_cbranch_scc1 K2_CLAIMEDC
    s_mov_b32 s88, s34
K2_CLAIMC:
    s_mov_b32 s51, s87
    s_mov_b32 s42, s87
    v_mov_b32 v241, s87
    s_lshr_b32 s48, s51, 1
    v_readlane_b32 s49, v16, s48
    s_and_b32 s50, s51, 1
    s_lshl_b32 s50, s50, 3
    s_lshr_b32 s49, s49, s50
    s_and_b32 s51, s49, 0xff
    v_mov_b32 v242, s51
    s_mov_b64 exec, 1
    ds_cmpst_rtn_b32 v243, v240, v241, v242
    s_mov_b64 exec, -1
    s_lshr_b32 s48, s51, 1
    v_readlane_b32 s49, v17, s48
    s_and_b32 s50, s51, 1
    s_lshl_b32 s50, s50, 4
    s_lshr_b32 s49, s49, s50
    s_and_b32 s46, s49, 0xffff
    s_mov_b32 s86, s51
    s_mov_b32 s51, s42
    s_lshr_b32 s48, s51, 1
    v_readlane_b32 s49, v17, s48
    s_and_b32 s50, s51, 1
    s_lshl_b32 s50, s50, 4
    s_lshr_b32 s49, s49, s50
    s_and_b32 s44, s49, 0xffff
    s_mov_b32 s51, s86
    s_waitcnt lgkmcnt(0)
    v_readfirstlane_b32 s87, v243
    s_nop 0
    s_cmp_lg_u32 s87, s42
    s_nop 1
    s_cbranch_scc1 K2_CLAIMC
K2_CLAIMEDC:
    s_sub_u32 s43, s51, s42
    s_add_u32 s47, s42, s29
    s_lshl_b32 s47, s47, 10
    s_cmp_eq_u32 s88, 0
    s_cselect_b32 s92, s4, s6
    s_cselect_b32 s93, s5, s7
    s_cselect_b32 s89, 1, 0
    s_cmp_ge_u32 s42, s100
    s_cselect_b32 s101, s89, 0
    s_sub_u32 s45, s46, s44
    s_min_u32 s45, s45, 16
    s_lshl_b32 s59, s44, 5
    v_add_u32 v26, s59, v9
    ds_read_b32 v26, v26
    v_cmp_gt_u32_e64 s[72:73], s45, v5
    s_waitcnt lgkmcnt(0)
    v_lshrrev_b32 v26, 2, v26
    v_add_u32 v26, v26, v7
    v_cndmask_b32_e64 v26, v18, v26, s[72:73]
    buffer_load_dwordx4 v[32:35], v26, s[96:99], 0 offen offset:0
    buffer_load_dwordx4 v[36:39], v26, s[96:99], 0 offen offset:64
    buffer_load_dwordx4 v[40:43], v26, s[96:99], 0 offen offset:128
    buffer_load_dwordx4 v[44:47], v26, s[96:99], 0 offen offset:192
    s_waitcnt vmcnt(16)
    buffer_store_dwordx4 v[96:99], v19, s[16:19], s41 offen offset:0 sc1
    buffer_store_dwordx4 v[100:103], v20, s[16:19], s41 offen offset:0 sc1
    s_waitcnt vmcnt(14)
    buffer_store_dwordx4 v[104:107], v19, s[16:19], s41 offen offset:256 sc1
    buffer_store_dwordx4 v[108:111], v20, s[16:19], s41 offen offset:256 sc1
    s_waitcnt vmcnt(12)
    buffer_store_dwordx4 v[112:115], v19, s[16:19], s41 offen offset:512 sc1
    buffer_store_dwordx4 v[116:119], v20, s[16:19], s41 offen offset:512 sc1
    s_waitcnt vmcnt(10)
    buffer_store_dwordx4 v[120:123], v19, s[16:19], s41 offen offset:768 sc1
    buffer_store_dwordx4 v[124:127], v20, s[16:19], s41 offen offset:768 sc1
    s_nop 0
    s_branch K2_LOOP
K2_DONE:
    s_cmp_eq_u32 s9, 0
    s_cbranch_scc1 K2_DONE2
    s_waitcnt vmcnt(0)
    s_barrier
    s_mov_b32 s9, 0
K2_DONE2:
    s_cmp_eq_u32 s35, 0
    s_cbranch_scc1 K2_END
    s_add_u32 s31, s31, s32
    s_mov_b32 s34, 1
    s_mov_b32 s1, 0
    s_waitcnt vmcnt(0)
    v_lshrrev_b32 v33, 1, v0
    v_lshlrev_b32 v33, 10, v33
    v_cmp_gt_u32 vcc, 250, v0
    s_nop 1
    v_cndmask_b32 v33, v18, v33, vcc
    s_lshl_b32 s48, s2, 2
    s_add_u32 s48, s48, 262144
    buffer_load_dword v34, v33, s[20:23], s48 offen
    s_waitcnt vmcnt(0)
    s_barrier
    v_lshlrev_b32 v36, 2, v0
    v_add_u32 v36, 102400, v36
    v_mov_b32 v37, 0
    v_mov_b32 v38, 103488
    v_cmp_gt_u32 vcc, 0x80, v0
    s_nop 0
    s_and_saveexec_b64 s[60:61], vcc
    ds_write_b32 v36, v37
    ds_write_b32 v38, v37
    ds_write_b32 v38, v37 offset:8
    s_mov_b64 exec, -1
    s_waitcnt lgkmcnt(0)
    s_branch K2_ROUND
K2_END:
    s_endpgm
.section .rodata,"a"
.p2align 6
.amdhsa_kernel edge_bin_kernel
  .amdhsa_next_free_vgpr 128
  .amdhsa_next_free_sgpr 96
  .amdhsa_accum_offset 128
  .amdhsa_group_segment_fixed_size 0
  .amdhsa_kernarg_size 88
  .amdhsa_user_sgpr_count 2
  .amdhsa_user_sgpr_kernarg_segment_ptr 1
  .amdhsa_system_sgpr_workgroup_id_x 1
  .amdhsa_float_denorm_mode_32 3
.end_amdhsa_kernel
.p2align 6
.amdhsa_kernel message_kernel
  .amdhsa_next_free_vgpr 256
  .amdhsa_next_free_sgpr 102
  .amdhsa_accum_offset 256
  .amdhsa_group_segment_fixed_size 0
  .amdhsa_kernarg_size 88
  .amdhsa_user_sgpr_count 2
  .amdhsa_user_sgpr_kernarg_segment_ptr 1
  .amdhsa_system_sgpr_workgroup_id_x 1
  .amdhsa_float_denorm_mode_32 3
.end_amdhsa_kernel
```
